```python
import torch

def _softmax(x, axis=-1):
    return torch.softmax(x, dim=axis)
def _gelu(x):
    return torch.nn.functional.gelu(x, approximate="tanh")
def _silu(x):
    return torch.nn.functional.silu(x)
def _sigmoid(x):
    return torch.sigmoid(x)
def _layernorm(x, axis=-1, eps=1e-5):
    m = x.mean(dim=axis, keepdim=True)
    v = x.var(dim=axis, keepdim=True, unbiased=False)
    return (x - m) / torch.sqrt(v + eps)
def _scatter_add(tgt, idx, src, axis=0):
    return tgt.clone().index_add_(axis, idx, src)
def _segment_sum(src, seg, n):
    out = torch.zeros((n,) + src.shape[1:], dtype=src.dtype)
    return out.index_add_(0, seg, src)
def _pad(x, pw):
    flat = tuple(v for pair in reversed(pw) for v in pair)
    return torch.nn.functional.pad(x, flat)

kernel_name = 'recurrent_scan__gqa_block_cached__dense_activation_gelu__decode'

def setup_inputs():

    _w = (lambda a: (lambda t: t.to(torch.bfloat16) if t.is_floating_point() else t)(torch.as_tensor(a)))
    def _A_setup():
        B, Sq, D = 8, 1, 512
        Hq, Hkv, Sk, Dh = 32, 8, 4096, 128
        assert Hq % Hkv == 0, (Hq, Hkv)
        return {
            "x": _w((lambda *s: torch.randn(*s, dtype=torch.bfloat16) * 0.05)(B, Sq, D)),
            "k_cache": _w((lambda *s: torch.randn(*s, dtype=torch.bfloat16) * 3.2)(B, Hkv, Sk, Dh)),
            "v_cache": _w((lambda *s: torch.randn(*s, dtype=torch.bfloat16) * 3.2)(B, Hkv, Sk, Dh)),
            "wq": _w((lambda *s: torch.randn(*s, dtype=torch.bfloat16) * 3.2)(D, Hq * Dh) * (D ** -0.5)),
            "wo": _w((lambda *s: torch.randn(*s, dtype=torch.bfloat16) * 3.2)(Hq * Dh, D) * ((Hq * Dh) ** -0.5)),
        }
    _A_in = _A_setup()

    def _B_setup():
        B, S, D, F = 8, 1, 512, 1792
        return {
            "x": _w((lambda *s: torch.randn(*s, dtype=torch.bfloat16) * 0.05)(B, S, D)),
            "w1": _w((lambda *s: torch.randn(*s, dtype=torch.bfloat16) * 3.2)(D, F) * (D ** -0.5)),
            "b1": _w((lambda *s: torch.randn(*s, dtype=torch.bfloat16) * 3.2)(F) * 0.01),
            "w2": _w((lambda *s: torch.randn(*s, dtype=torch.bfloat16) * 0.4)(F, D) * (F ** -0.5)),
            "b2": _w((lambda *s: torch.randn(*s, dtype=torch.bfloat16) * 0.4)(D) * 0.01),
        }
    _B_in = _B_setup()

    return {
        "A_x": _A_in["x"],
        "A_k_cache": _A_in["k_cache"],
        "A_v_cache": _A_in["v_cache"],
        "A_wq": _A_in["wq"],
        "A_wo": _A_in["wo"],
        "B_x": _B_in["x"],
        "B_w1": _B_in["w1"],
        "B_b1": _B_in["b1"],
        "B_w2": _B_in["w2"],
        "B_b2": _B_in["b2"],
    }

def reference(A_x, A_k_cache, A_v_cache, A_wq, A_wo, B_x, B_w1, B_b1, B_w2, B_b2):
    def _A_ref(x, k_cache, v_cache, wq, wo):
        B, Sq, D = x.shape
        Hq, Dh = 32, 128
        Hkv = k_cache.shape[1]
        rep = Hq // Hkv
        q = (lambda x, *d: x.permute(*d))((x @ wq).reshape(B, Sq, Hq, Dh), 0, 2, 1, 3)
        k = (lambda x, n, axis: torch.repeat_interleave(x, n, dim=axis))(k_cache, rep, axis=1)
        v = (lambda x, n, axis: torch.repeat_interleave(x, n, dim=axis))(v_cache, rep, axis=1)
        scores = torch.einsum("bhqd,bhkd->bhqk", q, k) * (Dh ** -0.5)
        p = _softmax(scores, axis=-1)
        o = torch.einsum("bhqk,bhkd->bhqd", p, v)
        return (lambda x, *d: x.permute(*d))(o, 0, 2, 1, 3).reshape(B, Sq, Hq * Dh) @ wo

    def _B_ref(x, w1, b1, w2, b2):
        h = torch.einsum("bsd,df->bsf", x, w1) + b1
        h = _gelu(h)
        return torch.einsum("bsf,fd->bsd", h, w2) + b2

    x = A_x
    xn = _layernorm(x, axis=-1)
    s = _A_ref(xn, A_k_cache, A_v_cache, A_wq, A_wo)
    g = _silu(_B_ref(xn, B_w1, B_b1, B_w2, B_b2))
    return x + s * g
```

```asm
; @launch kernel=k1_kernel grid=(368,1,1) block=(64,1,1) lds=0
; @launch kernel=k2_kernel grid=(256,1,1) block=(512,1,1) lds=20480
; @launch kernel=k3_kernel grid=(184,1,1) block=(256,1,1) lds=24576
; @launch kernel=k4_kernel grid=(16,1,1) block=(256,1,1) lds=0
.amdgcn_target "amdgcn-amd-amdhsa--gfx950"
.text
.globl k1_kernel
.p2align 8
.type k1_kernel,@function
k1_kernel:
    s_cmp_ge_u32 s2, 368
    s_cbranch_scc1 k1_end
    s_load_dwordx2 s[4:5], s[0:1], 0
    s_load_dwordx2 s[6:7], s[0:1], 24
    s_load_dwordx2 s[8:9], s[0:1], 48
    s_load_dwordx2 s[10:11], s[0:1], 96
    s_mov_b32 s20, 84148480
    s_mov_b32 s21, 117834498
    s_waitcnt lgkmcnt(0)
    v_lshlrev_b32 v1, 7, v0
    global_load_dwordx4 v[64:67], v1, s[4:5] offset:0
    global_load_dwordx4 v[68:71], v1, s[4:5] offset:16
    global_load_dwordx4 v[72:75], v1, s[4:5] offset:32
    global_load_dwordx4 v[76:79], v1, s[4:5] offset:48
    global_load_dwordx4 v[80:83], v1, s[4:5] offset:64
    global_load_dwordx4 v[84:87], v1, s[4:5] offset:80
    global_load_dwordx4 v[88:91], v1, s[4:5] offset:96
    global_load_dwordx4 v[92:95], v1, s[4:5] offset:112
    s_cmp_ge_u32 s2, 256
    s_cbranch_scc1 k1_ffn
    s_and_b32 s12, s2, 31
    s_lshr_b32 s13, s2, 5
    s_mov_b32 s14, 8192
    s_mov_b32 s15, 16384
    s_mul_i32 s16, s13, 131072
    s_add_u32 s10, s10, s16
    s_addc_u32 s11, s11, 0
    s_branch k1_go
k1_ffn:
    s_sub_u32 s16, s2, 256
    s_and_b32 s13, s16, 7
    s_lshr_b32 s12, s16, 3
    s_mov_b32 s14, 3584
    s_mov_b32 s15, 7168
    s_mov_b32 s6, s8
    s_mov_b32 s7, s9
    s_mul_i32 s16, s13, 57344
    s_add_u32 s16, s16, 1048576
    s_add_u32 s10, s10, s16
    s_addc_u32 s11, s11, 0
k1_go:
    s_lshl_b32 s16, s12, 8
    s_add_u32 s6, s6, s16
    s_addc_u32 s7, s7, 0
    s_lshl_b32 s16, s13, 6
    s_mul_i32 s16, s16, s14
    s_add_u32 s6, s6, s16
    s_addc_u32 s7, s7, 0
    s_lshl_b32 s16, s12, 9
    s_add_u32 s10, s10, s16
    s_addc_u32 s11, s11, 0
    v_lshrrev_b32 v2, 4, v0
    v_and_b32 v3, 15, v0
    s_lshl_b32 s17, s14, 3
    v_mul_lo_u32 v4, v2, s17
    v_lshl_add_u32 v4, v3, 4, v4
    s_mul_i32 s18, s14, 24
    global_load_dwordx4 v[128:131], v4, s[6:7]
    v_add_u32 v4, s14, v4
    global_load_dwordx4 v[132:135], v4, s[6:7]
    v_add_u32 v4, s14, v4
    global_load_dwordx4 v[136:139], v4, s[6:7]
    v_add_u32 v4, s14, v4
    global_load_dwordx4 v[140:143], v4, s[6:7]
    v_add_u32 v4, s14, v4
    global_load_dwordx4 v[144:147], v4, s[6:7]
    v_add_u32 v4, s14, v4
    global_load_dwordx4 v[148:151], v4, s[6:7]
    v_add_u32 v4, s14, v4
    global_load_dwordx4 v[152:155], v4, s[6:7]
    v_add_u32 v4, s14, v4
    global_load_dwordx4 v[156:159], v4, s[6:7]
    v_add_u32 v4, s14, v4
    v_add_u32 v4, s18, v4
    global_load_dwordx4 v[160:163], v4, s[6:7]
    v_add_u32 v4, s14, v4
    global_load_dwordx4 v[164:167], v4, s[6:7]
    v_add_u32 v4, s14, v4
    global_load_dwordx4 v[168:171], v4, s[6:7]
    v_add_u32 v4, s14, v4
    global_load_dwordx4 v[172:175], v4, s[6:7]
    v_add_u32 v4, s14, v4
    global_load_dwordx4 v[176:179], v4, s[6:7]
    v_add_u32 v4, s14, v4
    global_load_dwordx4 v[180:183], v4, s[6:7]
    v_add_u32 v4, s14, v4
    global_load_dwordx4 v[184:187], v4, s[6:7]
    v_add_u32 v4, s14, v4
    global_load_dwordx4 v[188:191], v4, s[6:7]
    v_add_u32 v4, s14, v4
    v_and_b32 v5, 7, v3
    v_lshlrev_b32 v5, 10, v5
    v_lshl_add_u32 v5, v2, 4, v5
    s_lshl_b32 s16, s13, 7
    v_add_u32 v5, s16, v5
    global_load_dwordx4 v[8:11], v5, s[4:5]
    global_load_dwordx4 v[12:15], v5, s[4:5] offset:64
    s_waitcnt vmcnt(18)
    v_lshlrev_b32 v192, 16, v64
    v_and_b32 v193, 0xffff0000, v64
    v_lshlrev_b32 v194, 16, v65
    v_and_b32 v195, 0xffff0000, v65
    v_lshlrev_b32 v196, 16, v66
    v_and_b32 v197, 0xffff0000, v66
    v_lshlrev_b32 v198, 16, v67
    v_and_b32 v199, 0xffff0000, v67
    v_lshlrev_b32 v200, 16, v68
    v_and_b32 v201, 0xffff0000, v68
    v_lshlrev_b32 v202, 16, v69
    v_and_b32 v203, 0xffff0000, v69
    v_lshlrev_b32 v204, 16, v70
    v_and_b32 v205, 0xffff0000, v70
    v_lshlrev_b32 v206, 16, v71
    v_and_b32 v207, 0xffff0000, v71
    v_lshlrev_b32 v208, 16, v72
    v_and_b32 v209, 0xffff0000, v72
    v_lshlrev_b32 v210, 16, v73
    v_and_b32 v211, 0xffff0000, v73
    v_lshlrev_b32 v212, 16, v74
    v_and_b32 v213, 0xffff0000, v74
    v_lshlrev_b32 v214, 16, v75
    v_and_b32 v215, 0xffff0000, v75
    v_lshlrev_b32 v216, 16, v76
    v_and_b32 v217, 0xffff0000, v76
    v_lshlrev_b32 v218, 16, v77
    v_and_b32 v219, 0xffff0000, v77
    v_lshlrev_b32 v220, 16, v78
    v_and_b32 v221, 0xffff0000, v78
    v_lshlrev_b32 v222, 16, v79
    v_and_b32 v223, 0xffff0000, v79
    v_lshlrev_b32 v224, 16, v80
    v_and_b32 v225, 0xffff0000, v80
    v_lshlrev_b32 v226, 16, v81
    v_and_b32 v227, 0xffff0000, v81
    v_lshlrev_b32 v228, 16, v82
    v_and_b32 v229, 0xffff0000, v82
    v_lshlrev_b32 v230, 16, v83
    v_and_b32 v231, 0xffff0000, v83
    v_lshlrev_b32 v232, 16, v84
    v_and_b32 v233, 0xffff0000, v84
    v_lshlrev_b32 v234, 16, v85
    v_and_b32 v235, 0xffff0000, v85
    v_lshlrev_b32 v236, 16, v86
    v_and_b32 v237, 0xffff0000, v86
    v_lshlrev_b32 v238, 16, v87
    v_and_b32 v239, 0xffff0000, v87
    v_lshlrev_b32 v240, 16, v88
    v_and_b32 v241, 0xffff0000, v88
    v_lshlrev_b32 v242, 16, v89
    v_and_b32 v243, 0xffff0000, v89
    v_lshlrev_b32 v244, 16, v90
    v_and_b32 v245, 0xffff0000, v90
    v_lshlrev_b32 v246, 16, v91
    v_and_b32 v247, 0xffff0000, v91
    v_lshlrev_b32 v248, 16, v92
    v_and_b32 v249, 0xffff0000, v92
    v_lshlrev_b32 v250, 16, v93
    v_and_b32 v251, 0xffff0000, v93
    v_lshlrev_b32 v252, 16, v94
    v_and_b32 v253, 0xffff0000, v94
    v_lshlrev_b32 v254, 16, v95
    v_and_b32 v255, 0xffff0000, v95
    v_mov_b32 v6, 0
    v_add_f32 v6, v6, v192
    v_add_f32 v6, v6, v193
    v_add_f32 v6, v6, v194
    v_add_f32 v6, v6, v195
    v_add_f32 v6, v6, v196
    v_add_f32 v6, v6, v197
    v_add_f32 v6, v6, v198
    v_add_f32 v6, v6, v199
    v_add_f32 v6, v6, v200
    v_add_f32 v6, v6, v201
    v_add_f32 v6, v6, v202
    v_add_f32 v6, v6, v203
    v_add_f32 v6, v6, v204
    v_add_f32 v6, v6, v205
    v_add_f32 v6, v6, v206
    v_add_f32 v6, v6, v207
    v_add_f32 v6, v6, v208
    v_add_f32 v6, v6, v209
    v_add_f32 v6, v6, v210
    v_add_f32 v6, v6, v211
    v_add_f32 v6, v6, v212
    v_add_f32 v6, v6, v213
    v_add_f32 v6, v6, v214
    v_add_f32 v6, v6, v215
    v_add_f32 v6, v6, v216
    v_add_f32 v6, v6, v217
    v_add_f32 v6, v6, v218
    v_add_f32 v6, v6, v219
    v_add_f32 v6, v6, v220
    v_add_f32 v6, v6, v221
    v_add_f32 v6, v6, v222
    v_add_f32 v6, v6, v223
    v_add_f32 v6, v6, v224
    v_add_f32 v6, v6, v225
    v_add_f32 v6, v6, v226
    v_add_f32 v6, v6, v227
    v_add_f32 v6, v6, v228
    v_add_f32 v6, v6, v229
    v_add_f32 v6, v6, v230
    v_add_f32 v6, v6, v231
    v_add_f32 v6, v6, v232
    v_add_f32 v6, v6, v233
    v_add_f32 v6, v6, v234
    v_add_f32 v6, v6, v235
    v_add_f32 v6, v6, v236
    v_add_f32 v6, v6, v237
    v_add_f32 v6, v6, v238
    v_add_f32 v6, v6, v239
    v_add_f32 v6, v6, v240
    v_add_f32 v6, v6, v241
    v_add_f32 v6, v6, v242
    v_add_f32 v6, v6, v243
    v_add_f32 v6, v6, v244
    v_add_f32 v6, v6, v245
    v_add_f32 v6, v6, v246
    v_add_f32 v6, v6, v247
    v_add_f32 v6, v6, v248
    v_add_f32 v6, v6, v249
    v_add_f32 v6, v6, v250
    v_add_f32 v6, v6, v251
    v_add_f32 v6, v6, v252
    v_add_f32 v6, v6, v253
    v_add_f32 v6, v6, v254
    v_add_f32 v6, v6, v255
    ds_swizzle_b32 v7, v6 offset:1055
    s_waitcnt lgkmcnt(0)
    v_add_f32 v6, v6, v7
    ds_swizzle_b32 v7, v6 offset:2079
    s_waitcnt lgkmcnt(0)
    v_add_f32 v6, v6, v7
    ds_swizzle_b32 v7, v6 offset:4127
    s_waitcnt lgkmcnt(0)
    v_add_f32 v6, v6, v7
    v_mul_f32 v6, 0x3b000000, v6
    v_mov_b32 v16, 0
    v_sub_f32 v7, v192, v6
    v_fmac_f32 v16, v7, v7
    v_sub_f32 v7, v193, v6
    v_fmac_f32 v16, v7, v7
    v_sub_f32 v7, v194, v6
    v_fmac_f32 v16, v7, v7
    v_sub_f32 v7, v195, v6
    v_fmac_f32 v16, v7, v7
    v_sub_f32 v7, v196, v6
    v_fmac_f32 v16, v7, v7
    v_sub_f32 v7, v197, v6
    v_fmac_f32 v16, v7, v7
    v_sub_f32 v7, v198, v6
    v_fmac_f32 v16, v7, v7
    v_sub_f32 v7, v199, v6
    v_fmac_f32 v16, v7, v7
    v_sub_f32 v7, v200, v6
    v_fmac_f32 v16, v7, v7
    v_sub_f32 v7, v201, v6
    v_fmac_f32 v16, v7, v7
    v_sub_f32 v7, v202, v6
    v_fmac_f32 v16, v7, v7
    v_sub_f32 v7, v203, v6
    v_fmac_f32 v16, v7, v7
    v_sub_f32 v7, v204, v6
    v_fmac_f32 v16, v7, v7
    v_sub_f32 v7, v205, v6
    v_fmac_f32 v16, v7, v7
    v_sub_f32 v7, v206, v6
    v_fmac_f32 v16, v7, v7
    v_sub_f32 v7, v207, v6
    v_fmac_f32 v16, v7, v7
    v_sub_f32 v7, v208, v6
    v_fmac_f32 v16, v7, v7
    v_sub_f32 v7, v209, v6
    v_fmac_f32 v16, v7, v7
    v_sub_f32 v7, v210, v6
    v_fmac_f32 v16, v7, v7
    v_sub_f32 v7, v211, v6
    v_fmac_f32 v16, v7, v7
    v_sub_f32 v7, v212, v6
    v_fmac_f32 v16, v7, v7
    v_sub_f32 v7, v213, v6
    v_fmac_f32 v16, v7, v7
    v_sub_f32 v7, v214, v6
    v_fmac_f32 v16, v7, v7
    v_sub_f32 v7, v215, v6
    v_fmac_f32 v16, v7, v7
    v_sub_f32 v7, v216, v6
    v_fmac_f32 v16, v7, v7
    v_sub_f32 v7, v217, v6
    v_fmac_f32 v16, v7, v7
    v_sub_f32 v7, v218, v6
    v_fmac_f32 v16, v7, v7
    v_sub_f32 v7, v219, v6
    v_fmac_f32 v16, v7, v7
    v_sub_f32 v7, v220, v6
    v_fmac_f32 v16, v7, v7
    v_sub_f32 v7, v221, v6
    v_fmac_f32 v16, v7, v7
    v_sub_f32 v7, v222, v6
    v_fmac_f32 v16, v7, v7
    v_sub_f32 v7, v223, v6
    v_fmac_f32 v16, v7, v7
    v_sub_f32 v7, v224, v6
    v_fmac_f32 v16, v7, v7
    v_sub_f32 v7, v225, v6
    v_fmac_f32 v16, v7, v7
    v_sub_f32 v7, v226, v6
    v_fmac_f32 v16, v7, v7
    v_sub_f32 v7, v227, v6
    v_fmac_f32 v16, v7, v7
    v_sub_f32 v7, v228, v6
    v_fmac_f32 v16, v7, v7
    v_sub_f32 v7, v229, v6
    v_fmac_f32 v16, v7, v7
    v_sub_f32 v7, v230, v6
    v_fmac_f32 v16, v7, v7
    v_sub_f32 v7, v231, v6
    v_fmac_f32 v16, v7, v7
    v_sub_f32 v7, v232, v6
    v_fmac_f32 v16, v7, v7
    v_sub_f32 v7, v233, v6
    v_fmac_f32 v16, v7, v7
    v_sub_f32 v7, v234, v6
    v_fmac_f32 v16, v7, v7
    v_sub_f32 v7, v235, v6
    v_fmac_f32 v16, v7, v7
    v_sub_f32 v7, v236, v6
    v_fmac_f32 v16, v7, v7
    v_sub_f32 v7, v237, v6
    v_fmac_f32 v16, v7, v7
    v_sub_f32 v7, v238, v6
    v_fmac_f32 v16, v7, v7
    v_sub_f32 v7, v239, v6
    v_fmac_f32 v16, v7, v7
    v_sub_f32 v7, v240, v6
    v_fmac_f32 v16, v7, v7
    v_sub_f32 v7, v241, v6
    v_fmac_f32 v16, v7, v7
    v_sub_f32 v7, v242, v6
    v_fmac_f32 v16, v7, v7
    v_sub_f32 v7, v243, v6
    v_fmac_f32 v16, v7, v7
    v_sub_f32 v7, v244, v6
    v_fmac_f32 v16, v7, v7
    v_sub_f32 v7, v245, v6
    v_fmac_f32 v16, v7, v7
    v_sub_f32 v7, v246, v6
    v_fmac_f32 v16, v7, v7
    v_sub_f32 v7, v247, v6
    v_fmac_f32 v16, v7, v7
    v_sub_f32 v7, v248, v6
    v_fmac_f32 v16, v7, v7
    v_sub_f32 v7, v249, v6
    v_fmac_f32 v16, v7, v7
    v_sub_f32 v7, v250, v6
    v_fmac_f32 v16, v7, v7
    v_sub_f32 v7, v251, v6
    v_fmac_f32 v16, v7, v7
    v_sub_f32 v7, v252, v6
    v_fmac_f32 v16, v7, v7
    v_sub_f32 v7, v253, v6
    v_fmac_f32 v16, v7, v7
    v_sub_f32 v7, v254, v6
    v_fmac_f32 v16, v7, v7
    v_sub_f32 v7, v255, v6
    v_fmac_f32 v16, v7, v7
    ds_swizzle_b32 v7, v16 offset:1055
    s_waitcnt lgkmcnt(0)
    v_add_f32 v16, v16, v7
    ds_swizzle_b32 v7, v16 offset:2079
    s_waitcnt lgkmcnt(0)
    v_add_f32 v16, v16, v7
    ds_swizzle_b32 v7, v16 offset:4127
    s_waitcnt lgkmcnt(0)
    v_add_f32 v16, v16, v7
    v_mul_f32 v16, 0x3b000000, v16
    v_cvt_pk_bf16_f32 v7, v6, v6
    v_lshlrev_b32 v6, 16, v7
    v_cvt_pk_bf16_f32 v7, v16, v16
    v_lshlrev_b32 v16, 16, v7
    v_add_f32 v16, 0x3727c5ac, v16
    v_cvt_pk_bf16_f32 v7, v16, v16
    v_lshlrev_b32 v16, 16, v7
    v_sqrt_f32 v16, v16
    s_nop 0
    v_cvt_pk_bf16_f32 v7, v16, v16
    v_lshlrev_b32 v16, 16, v7
    v_rcp_f32 v16, v16
    v_and_b32 v7, 7, v3
    v_lshlrev_b32 v7, 5, v7
    ds_bpermute_b32 v17, v7, v6
    ds_bpermute_b32 v18, v7, v16
    s_waitcnt vmcnt(0) lgkmcnt(0)
    v_cmp_gt_u32 vcc, 8, v3
    v_lshlrev_b32 v20, 16, v8
    v_and_b32 v21, 0xffff0000, v8
    v_sub_f32 v20, v20, v17
    v_cvt_pk_bf16_f32 v22, v20, v20
    v_lshlrev_b32 v20, 16, v22
    v_mul_f32 v20, v20, v18
    v_sub_f32 v21, v21, v17
    v_cvt_pk_bf16_f32 v22, v21, v21
    v_lshlrev_b32 v21, 16, v22
    v_mul_f32 v21, v21, v18
    v_cvt_pk_bf16_f32 v8, v20, v21
    v_cndmask_b32 v8, 0, v8, vcc
    v_lshlrev_b32 v20, 16, v9
    v_and_b32 v21, 0xffff0000, v9
    v_sub_f32 v20, v20, v17
    v_cvt_pk_bf16_f32 v22, v20, v20
    v_lshlrev_b32 v20, 16, v22
    v_mul_f32 v20, v20, v18
    v_sub_f32 v21, v21, v17
    v_cvt_pk_bf16_f32 v22, v21, v21
    v_lshlrev_b32 v21, 16, v22
    v_mul_f32 v21, v21, v18
    v_cvt_pk_bf16_f32 v9, v20, v21
    v_cndmask_b32 v9, 0, v9, vcc
    v_lshlrev_b32 v20, 16, v10
    v_and_b32 v21, 0xffff0000, v10
    v_sub_f32 v20, v20, v17
    v_cvt_pk_bf16_f32 v22, v20, v20
    v_lshlrev_b32 v20, 16, v22
    v_mul_f32 v20, v20, v18
    v_sub_f32 v21, v21, v17
    v_cvt_pk_bf16_f32 v22, v21, v21
    v_lshlrev_b32 v21, 16, v22
    v_mul_f32 v21, v21, v18
    v_cvt_pk_bf16_f32 v10, v20, v21
    v_cndmask_b32 v10, 0, v10, vcc
    v_lshlrev_b32 v20, 16, v11
    v_and_b32 v21, 0xffff0000, v11
    v_sub_f32 v20, v20, v17
    v_cvt_pk_bf16_f32 v22, v20, v20
    v_lshlrev_b32 v20, 16, v22
    v_mul_f32 v20, v20, v18
    v_sub_f32 v21, v21, v17
    v_cvt_pk_bf16_f32 v22, v21, v21
    v_lshlrev_b32 v21, 16, v22
    v_mul_f32 v21, v21, v18
    v_cvt_pk_bf16_f32 v11, v20, v21
    v_cndmask_b32 v11, 0, v11, vcc
    v_lshlrev_b32 v20, 16, v12
    v_and_b32 v21, 0xffff0000, v12
    v_sub_f32 v20, v20, v17
    v_cvt_pk_bf16_f32 v22, v20, v20
    v_lshlrev_b32 v20, 16, v22
    v_mul_f32 v20, v20, v18
    v_sub_f32 v21, v21, v17
    v_cvt_pk_bf16_f32 v22, v21, v21
    v_lshlrev_b32 v21, 16, v22
    v_mul_f32 v21, v21, v18
    v_cvt_pk_bf16_f32 v12, v20, v21
    v_cndmask_b32 v12, 0, v12, vcc
    v_lshlrev_b32 v20, 16, v13
    v_and_b32 v21, 0xffff0000, v13
    v_sub_f32 v20, v20, v17
    v_cvt_pk_bf16_f32 v22, v20, v20
    v_lshlrev_b32 v20, 16, v22
    v_mul_f32 v20, v20, v18
    v_sub_f32 v21, v21, v17
    v_cvt_pk_bf16_f32 v22, v21, v21
    v_lshlrev_b32 v21, 16, v22
    v_mul_f32 v21, v21, v18
    v_cvt_pk_bf16_f32 v13, v20, v21
    v_cndmask_b32 v13, 0, v13, vcc
    v_lshlrev_b32 v20, 16, v14
    v_and_b32 v21, 0xffff0000, v14
    v_sub_f32 v20, v20, v17
    v_cvt_pk_bf16_f32 v22, v20, v20
    v_lshlrev_b32 v20, 16, v22
    v_mul_f32 v20, v20, v18
    v_sub_f32 v21, v21, v17
    v_cvt_pk_bf16_f32 v22, v21, v21
    v_lshlrev_b32 v21, 16, v22
    v_mul_f32 v21, v21, v18
    v_cvt_pk_bf16_f32 v14, v20, v21
    v_cndmask_b32 v14, 0, v14, vcc
    v_lshlrev_b32 v20, 16, v15
    v_and_b32 v21, 0xffff0000, v15
    v_sub_f32 v20, v20, v17
    v_cvt_pk_bf16_f32 v22, v20, v20
    v_lshlrev_b32 v20, 16, v22
    v_mul_f32 v20, v20, v18
    v_sub_f32 v21, v21, v17
    v_cvt_pk_bf16_f32 v22, v21, v21
    v_lshlrev_b32 v21, 16, v22
    v_mul_f32 v21, v21, v18
    v_cvt_pk_bf16_f32 v15, v20, v21
    v_cndmask_b32 v15, 0, v15, vcc
    v_mov_b32 v32, 0
    v_mov_b32 v33, 0
    v_mov_b32 v34, 0
    v_mov_b32 v35, 0
    v_mov_b32 v36, 0
    v_mov_b32 v37, 0
    v_mov_b32 v38, 0
    v_mov_b32 v39, 0
    v_mov_b32 v40, 0
    v_mov_b32 v41, 0
    v_mov_b32 v42, 0
    v_mov_b32 v43, 0
    v_mov_b32 v44, 0
    v_mov_b32 v45, 0
    v_mov_b32 v46, 0
    v_mov_b32 v47, 0
    v_mov_b32 v48, 0
    v_mov_b32 v49, 0
    v_mov_b32 v50, 0
    v_mov_b32 v51, 0
    v_mov_b32 v52, 0
    v_mov_b32 v53, 0
    v_mov_b32 v54, 0
    v_mov_b32 v55, 0
    v_mov_b32 v56, 0
    v_mov_b32 v57, 0
    v_mov_b32 v58, 0
    v_mov_b32 v59, 0
    v_mov_b32 v60, 0
    v_mov_b32 v61, 0
    v_mov_b32 v62, 0
    v_mov_b32 v63, 0
    v_perm_b32 v24, v132, v128, s20
    v_perm_b32 v25, v140, v136, s20
    v_perm_b32 v26, v148, v144, s20
    v_perm_b32 v27, v156, v152, s20
    s_nop 1
    v_mfma_f32_16x16x32_bf16 v[32:35], v[8:11], v[24:27], v[32:35]
    v_perm_b32 v28, v132, v128, s21
    v_perm_b32 v29, v140, v136, s21
    v_perm_b32 v30, v148, v144, s21
    v_perm_b32 v31, v156, v152, s21
    s_nop 1
    v_mfma_f32_16x16x32_bf16 v[36:39], v[8:11], v[28:31], v[36:39]
    v_perm_b32 v24, v133, v129, s20
    v_perm_b32 v25, v141, v137, s20
    v_perm_b32 v26, v149, v145, s20
    v_perm_b32 v27, v157, v153, s20
    s_nop 1
    v_mfma_f32_16x16x32_bf16 v[40:43], v[8:11], v[24:27], v[40:43]
    v_perm_b32 v28, v133, v129, s21
    v_perm_b32 v29, v141, v137, s21
    v_perm_b32 v30, v149, v145, s21
    v_perm_b32 v31, v157, v153, s21
    s_nop 1
    v_mfma_f32_16x16x32_bf16 v[44:47], v[8:11], v[28:31], v[44:47]
    v_perm_b32 v24, v134, v130, s20
    v_perm_b32 v25, v142, v138, s20
    v_perm_b32 v26, v150, v146, s20
    v_perm_b32 v27, v158, v154, s20
    s_nop 1
    v_mfma_f32_16x16x32_bf16 v[48:51], v[8:11], v[24:27], v[48:51]
    v_perm_b32 v28, v134, v130, s21
    v_perm_b32 v29, v142, v138, s21
    v_perm_b32 v30, v150, v146, s21
    v_perm_b32 v31, v158, v154, s21
    s_nop 1
    v_mfma_f32_16x16x32_bf16 v[52:55], v[8:11], v[28:31], v[52:55]
    v_perm_b32 v24, v135, v131, s20
    v_perm_b32 v25, v143, v139, s20
    v_perm_b32 v26, v151, v147, s20
    v_perm_b32 v27, v159, v155, s20
    s_nop 1
    v_mfma_f32_16x16x32_bf16 v[56:59], v[8:11], v[24:27], v[56:59]
    v_perm_b32 v28, v135, v131, s21
    v_perm_b32 v29, v143, v139, s21
    v_perm_b32 v30, v151, v147, s21
    v_perm_b32 v31, v159, v155, s21
    s_nop 1
    v_mfma_f32_16x16x32_bf16 v[60:63], v[8:11], v[28:31], v[60:63]
    v_perm_b32 v24, v164, v160, s20
    v_perm_b32 v25, v172, v168, s20
    v_perm_b32 v26, v180, v176, s20
    v_perm_b32 v27, v188, v184, s20
    s_nop 1
    v_mfma_f32_16x16x32_bf16 v[32:35], v[12:15], v[24:27], v[32:35]
    v_perm_b32 v28, v164, v160, s21
    v_perm_b32 v29, v172, v168, s21
    v_perm_b32 v30, v180, v176, s21
    v_perm_b32 v31, v188, v184, s21
    s_nop 1
    v_mfma_f32_16x16x32_bf16 v[36:39], v[12:15], v[28:31], v[36:39]
    v_perm_b32 v24, v165, v161, s20
    v_perm_b32 v25, v173, v169, s20
    v_perm_b32 v26, v181, v177, s20
    v_perm_b32 v27, v189, v185, s20
    s_nop 1
    v_mfma_f32_16x16x32_bf16 v[40:43], v[12:15], v[24:27], v[40:43]
    v_perm_b32 v28, v165, v161, s21
    v_perm_b32 v29, v173, v169, s21
    v_perm_b32 v30, v181, v177, s21
    v_perm_b32 v31, v189, v185, s21
    s_nop 1
    v_mfma_f32_16x16x32_bf16 v[44:47], v[12:15], v[28:31], v[44:47]
    v_perm_b32 v24, v166, v162, s20
    v_perm_b32 v25, v174, v170, s20
    v_perm_b32 v26, v182, v178, s20
    v_perm_b32 v27, v190, v186, s20
    s_nop 1
    v_mfma_f32_16x16x32_bf16 v[48:51], v[12:15], v[24:27], v[48:51]
    v_perm_b32 v28, v166, v162, s21
    v_perm_b32 v29, v174, v170, s21
    v_perm_b32 v30, v182, v178, s21
    v_perm_b32 v31, v190, v186, s21
    s_nop 1
    v_mfma_f32_16x16x32_bf16 v[52:55], v[12:15], v[28:31], v[52:55]
    v_perm_b32 v24, v167, v163, s20
    v_perm_b32 v25, v175, v171, s20
    v_perm_b32 v26, v183, v179, s20
    v_perm_b32 v27, v191, v187, s20
    s_nop 1
    v_mfma_f32_16x16x32_bf16 v[56:59], v[12:15], v[24:27], v[56:59]
    v_perm_b32 v28, v167, v163, s21
    v_perm_b32 v29, v175, v171, s21
    v_perm_b32 v30, v183, v179, s21
    v_perm_b32 v31, v191, v187, s21
    s_nop 1
    v_mfma_f32_16x16x32_bf16 v[60:63], v[12:15], v[28:31], v[60:63]
    s_nop 7
    s_nop 1
    v_cmp_gt_u32 vcc, 32, v0
    s_and_saveexec_b64 s[22:23], vcc
    v_lshlrev_b32 v5, 2, v2
    v_mul_lo_u32 v5, v5, s15
    v_lshl_add_u32 v5, v3, 5, v5
    v_mov_b32 v64, v32
    v_mov_b32 v65, v36
    v_mov_b32 v66, v40
    v_mov_b32 v67, v44
    v_mov_b32 v68, v48
    v_mov_b32 v69, v52
    v_mov_b32 v70, v56
    v_mov_b32 v71, v60
    global_store_dwordx4 v5, v[64:67], s[10:11]
    global_store_dwordx4 v5, v[68:71], s[10:11] offset:16
    v_add_u32 v5, s15, v5
    s_nop 1
    v_mov_b32 v64, v33
    v_mov_b32 v65, v37
    v_mov_b32 v66, v41
    v_mov_b32 v67, v45
    v_mov_b32 v68, v49
    v_mov_b32 v69, v53
    v_mov_b32 v70, v57
    v_mov_b32 v71, v61
    global_store_dwordx4 v5, v[64:67], s[10:11]
    global_store_dwordx4 v5, v[68:71], s[10:11] offset:16
    v_add_u32 v5, s15, v5
    s_nop 1
    v_mov_b32 v64, v34
    v_mov_b32 v65, v38
    v_mov_b32 v66, v42
    v_mov_b32 v67, v46
    v_mov_b32 v68, v50
    v_mov_b32 v69, v54
    v_mov_b32 v70, v58
    v_mov_b32 v71, v62
    global_store_dwordx4 v5, v[64:67], s[10:11]
    global_store_dwordx4 v5, v[68:71], s[10:11] offset:16
    v_add_u32 v5, s15, v5
    s_nop 1
    v_mov_b32 v64, v35
    v_mov_b32 v65, v39
    v_mov_b32 v66, v43
    v_mov_b32 v67, v47
    v_mov_b32 v68, v51
    v_mov_b32 v69, v55
    v_mov_b32 v70, v59
    v_mov_b32 v71, v63
    global_store_dwordx4 v5, v[64:67], s[10:11]
    global_store_dwordx4 v5, v[68:71], s[10:11] offset:16
    v_add_u32 v5, s15, v5
    s_nop 1
k1_end:
    s_endpgm
.globl k2_kernel
.p2align 8
.type k2_kernel,@function
k2_kernel:
    s_cmp_ge_u32 s2, 256
    s_cbranch_scc1 k2_end
    s_load_dwordx2 s[4:5], s[0:1], 8
    s_load_dwordx2 s[6:7], s[0:1], 16
    s_load_dwordx2 s[10:11], s[0:1], 96
    s_mov_b32 s20, 84148480
    s_mov_b32 s21, 117834498
    s_lshr_b32 s12, s2, 2
    s_and_b32 s13, s2, 3
    v_lshrrev_b32 v1, 6, v0
    s_nop 0
    v_readfirstlane_b32 s14, v1
    v_and_b32 v1, 63, v0
    v_lshrrev_b32 v2, 4, v1
    v_and_b32 v3, 15, v1
    s_waitcnt lgkmcnt(0)
    s_lshl_b32 s15, s12, 20
    s_lshl_b32 s16, s13, 18
    s_add_u32 s15, s15, s16
    s_lshl_b32 s16, s14, 15
    s_add_u32 s15, s15, s16
    s_add_u32 s4, s4, s15
    s_addc_u32 s5, s5, 0
    s_add_u32 s6, s6, s15
    s_addc_u32 s7, s7, 0
    v_lshrrev_b32 v4, 2, v3
    v_lshlrev_b32 v4, 3, v4
    v_and_b32 v5, 3, v3
    v_add_u32 v4, v4, v5
    v_lshlrev_b32 v4, 8, v4
    v_lshl_add_u32 v4, v2, 4, v4
    v_lshlrev_b32 v5, 11, v2
    v_lshl_add_u32 v5, v3, 4, v5
    global_load_dwordx4 v[64:67], v4, s[4:5] offset:0
    global_load_dwordx4 v[68:71], v4, s[4:5] offset:64
    global_load_dwordx4 v[72:75], v4, s[4:5] offset:128
    global_load_dwordx4 v[76:79], v4, s[4:5] offset:192
    global_load_dwordx4 v[80:83], v4, s[4:5] offset:1024
    global_load_dwordx4 v[84:87], v4, s[4:5] offset:1088
    global_load_dwordx4 v[88:91], v4, s[4:5] offset:1152
    global_load_dwordx4 v[92:95], v4, s[4:5] offset:1216
    s_add_u32 s4, s4, 8192
    s_addc_u32 s5, s5, 0
    global_load_dwordx4 v[96:99], v4, s[4:5] offset:0
    global_load_dwordx4 v[100:103], v4, s[4:5] offset:64
    global_load_dwordx4 v[104:107], v4, s[4:5] offset:128
    global_load_dwordx4 v[108:111], v4, s[4:5] offset:192
    global_load_dwordx4 v[112:115], v4, s[4:5] offset:1024
    global_load_dwordx4 v[116:119], v4, s[4:5] offset:1088
    global_load_dwordx4 v[120:123], v4, s[4:5] offset:1152
    global_load_dwordx4 v[124:127], v4, s[4:5] offset:1216
    s_add_u32 s4, s4, 8192
    s_addc_u32 s5, s5, 0
    global_load_dwordx4 v[128:131], v5, s[6:7] offset:0
    global_load_dwordx4 v[132:135], v5, s[6:7] offset:256
    global_load_dwordx4 v[136:139], v5, s[6:7] offset:512
    global_load_dwordx4 v[140:143], v5, s[6:7] offset:768
    global_load_dwordx4 v[144:147], v5, s[6:7] offset:1024
    global_load_dwordx4 v[148:151], v5, s[6:7] offset:1280
    global_load_dwordx4 v[152:155], v5, s[6:7] offset:1536
    global_load_dwordx4 v[156:159], v5, s[6:7] offset:1792
    s_add_u32 s6, s6, 8192
    s_addc_u32 s7, s7, 0
    global_load_dwordx4 v[160:163], v5, s[6:7] offset:0
    global_load_dwordx4 v[164:167], v5, s[6:7] offset:256
    global_load_dwordx4 v[168:171], v5, s[6:7] offset:512
    global_load_dwordx4 v[172:175], v5, s[6:7] offset:768
    global_load_dwordx4 v[176:179], v5, s[6:7] offset:1024
    global_load_dwordx4 v[180:183], v5, s[6:7] offset:1280
    global_load_dwordx4 v[184:187], v5, s[6:7] offset:1536
    global_load_dwordx4 v[188:191], v5, s[6:7] offset:1792
    s_add_u32 s6, s6, 8192
    s_addc_u32 s7, s7, 0
    s_lshr_b32 s16, s12, 3
    s_and_b32 s17, s12, 7
    s_lshl_b32 s16, s16, 14
    s_lshl_b32 s17, s17, 11
    s_add_u32 s16, s16, s17
    v_lshlrev_b32 v6, 2, v0
    v_add_u32 v6, s16, v6
    global_load_dword v16, v6, s[10:11]
    v_add_u32 v6, 0x20000, v6
    global_load_dword v17, v6, s[10:11]
    v_add_u32 v6, 0x20000, v6
    global_load_dword v18, v6, s[10:11]
    v_add_u32 v6, 0x20000, v6
    global_load_dword v19, v6, s[10:11]
    v_add_u32 v6, 0x20000, v6
    global_load_dword v20, v6, s[10:11]
    v_add_u32 v6, 0x20000, v6
    global_load_dword v21, v6, s[10:11]
    v_add_u32 v6, 0x20000, v6
    global_load_dword v22, v6, s[10:11]
    v_add_u32 v6, 0x20000, v6
    global_load_dword v23, v6, s[10:11]
    v_add_u32 v6, 0x20000, v6
    s_waitcnt vmcnt(0)
    v_add_f32 v16, v16, v17
    v_add_f32 v16, v16, v18
    v_add_f32 v16, v16, v19
    v_add_f32 v16, v16, v20
    v_add_f32 v16, v16, v21
    v_add_f32 v16, v16, v22
    v_add_f32 v16, v16, v23
    v_cvt_pk_bf16_f32 v16, v16, v16
    v_lshlrev_b32 v6, 1, v0
    ds_write_b16 v6, v16
    s_waitcnt lgkmcnt(0)
    s_barrier
    v_and_b32 v6, 3, v3
    v_lshlrev_b32 v6, 8, v6
    v_lshl_add_u32 v6, v2, 4, v6
    ds_read_b128 v[8:11], v6 offset:0
    ds_read_b128 v[12:15], v6 offset:64
    ds_read_b128 v[16:19], v6 offset:128
    ds_read_b128 v[20:23], v6 offset:192
    v_cmp_gt_u32 vcc, 4, v3
    s_waitcnt lgkmcnt(0)
    s_barrier
    v_cndmask_b32 v8, 0, v8, vcc
    v_cndmask_b32 v9, 0, v9, vcc
    v_cndmask_b32 v10, 0, v10, vcc
    v_cndmask_b32 v11, 0, v11, vcc
    v_cndmask_b32 v12, 0, v12, vcc
    v_cndmask_b32 v13, 0, v13, vcc
    v_cndmask_b32 v14, 0, v14, vcc
    v_cndmask_b32 v15, 0, v15, vcc
    v_cndmask_b32 v16, 0, v16, vcc
    v_cndmask_b32 v17, 0, v17, vcc
    v_cndmask_b32 v18, 0, v18, vcc
    v_cndmask_b32 v19, 0, v19, vcc
    v_cndmask_b32 v20, 0, v20, vcc
    v_cndmask_b32 v21, 0, v21, vcc
    v_cndmask_b32 v22, 0, v22, vcc
    v_cndmask_b32 v23, 0, v23, vcc
    v_mov_b32 v224, 0
    v_mov_b32 v225, 0
    v_mov_b32 v226, 0
    v_mov_b32 v227, 0
    v_mov_b32 v228, 0
    v_mov_b32 v229, 0
    v_mov_b32 v230, 0
    v_mov_b32 v231, 0
    v_mov_b32 v232, 0
    v_mov_b32 v233, 0
    v_mov_b32 v234, 0
    v_mov_b32 v235, 0
    v_mov_b32 v236, 0
    v_mov_b32 v237, 0
    v_mov_b32 v238, 0
    v_mov_b32 v239, 0
    v_mov_b32 v240, 0
    v_mov_b32 v241, 0
    v_mov_b32 v242, 0
    v_mov_b32 v243, 0
    v_mov_b32 v244, 0
    v_mov_b32 v245, 0
    v_mov_b32 v246, 0
    v_mov_b32 v247, 0
    v_mov_b32 v248, 0
    v_mov_b32 v249, 0
    v_mov_b32 v250, 0
    v_mov_b32 v251, 0
    v_mov_b32 v252, 0
    v_mov_b32 v253, 0
    v_mov_b32 v254, 0
    v_mov_b32 v255, 0
    v_mov_b32 v192, 0
    v_mov_b32 v193, 0
    v_mov_b32 v194, 0
    v_mov_b32 v195, 0
    s_nop 1
    v_mfma_f32_16x16x32_bf16 v[192:195], v[64:67], v[8:11], v[192:195]
    v_mfma_f32_16x16x32_bf16 v[192:195], v[68:71], v[12:15], v[192:195]
    v_mfma_f32_16x16x32_bf16 v[192:195], v[72:75], v[16:19], v[192:195]
    v_mfma_f32_16x16x32_bf16 v[192:195], v[76:79], v[20:23], v[192:195]
    v_mov_b32 v196, 0
    v_mov_b32 v197, 0
    v_mov_b32 v198, 0
    v_mov_b32 v199, 0
    s_nop 1
    v_mfma_f32_16x16x32_bf16 v[196:199], v[80:83], v[8:11], v[196:199]
    v_mfma_f32_16x16x32_bf16 v[196:199], v[84:87], v[12:15], v[196:199]
    v_mfma_f32_16x16x32_bf16 v[196:199], v[88:91], v[16:19], v[196:199]
    v_mfma_f32_16x16x32_bf16 v[196:199], v[92:95], v[20:23], v[196:199]
    global_load_dwordx4 v[64:67], v4, s[4:5] offset:0
    global_load_dwordx4 v[68:71], v4, s[4:5] offset:64
    global_load_dwordx4 v[72:75], v4, s[4:5] offset:128
    global_load_dwordx4 v[76:79], v4, s[4:5] offset:192
    global_load_dwordx4 v[80:83], v4, s[4:5] offset:1024
    global_load_dwordx4 v[84:87], v4, s[4:5] offset:1088
    global_load_dwordx4 v[88:91], v4, s[4:5] offset:1152
    global_load_dwordx4 v[92:95], v4, s[4:5] offset:1216
    s_add_u32 s4, s4, 8192
    s_addc_u32 s5, s5, 0
    v_mov_b32 v200, 0
    v_mov_b32 v201, 0
    v_mov_b32 v202, 0
    v_mov_b32 v203, 0
    s_nop 1
    v_mfma_f32_16x16x32_bf16 v[200:203], v[96:99], v[8:11], v[200:203]
    v_mfma_f32_16x16x32_bf16 v[200:203], v[100:103], v[12:15], v[200:203]
    v_mfma_f32_16x16x32_bf16 v[200:203], v[104:107], v[16:19], v[200:203]
    v_mfma_f32_16x16x32_bf16 v[200:203], v[108:111], v[20:23], v[200:203]
    v_mov_b32 v204, 0
    v_mov_b32 v205, 0
    v_mov_b32 v206, 0
    v_mov_b32 v207, 0
    s_nop 1
    v_mfma_f32_16x16x32_bf16 v[204:207], v[112:115], v[8:11], v[204:207]
    v_mfma_f32_16x16x32_bf16 v[204:207], v[116:119], v[12:15], v[204:207]
    v_mfma_f32_16x16x32_bf16 v[204:207], v[120:123], v[16:19], v[204:207]
    v_mfma_f32_16x16x32_bf16 v[204:207], v[124:127], v[20:23], v[204:207]
    global_load_dwordx4 v[96:99], v4, s[4:5] offset:0
    global_load_dwordx4 v[100:103], v4, s[4:5] offset:64
    global_load_dwordx4 v[104:107], v4, s[4:5] offset:128
    global_load_dwordx4 v[108:111], v4, s[4:5] offset:192
    global_load_dwordx4 v[112:115], v4, s[4:5] offset:1024
    global_load_dwordx4 v[116:119], v4, s[4:5] offset:1088
    global_load_dwordx4 v[120:123], v4, s[4:5] offset:1152
    global_load_dwordx4 v[124:127], v4, s[4:5] offset:1216
    s_add_u32 s4, s4, 8192
    s_addc_u32 s5, s5, 0
    s_waitcnt vmcnt(8)
    v_mov_b32 v208, 0
    v_mov_b32 v209, 0
    v_mov_b32 v210, 0
    v_mov_b32 v211, 0
    s_nop 1
    v_mfma_f32_16x16x32_bf16 v[208:211], v[64:67], v[8:11], v[208:211]
    v_mfma_f32_16x16x32_bf16 v[208:211], v[68:71], v[12:15], v[208:211]
    v_mfma_f32_16x16x32_bf16 v[208:211], v[72:75], v[16:19], v[208:211]
    v_mfma_f32_16x16x32_bf16 v[208:211], v[76:79], v[20:23], v[208:211]
    v_mov_b32 v212, 0
    v_mov_b32 v213, 0
    v_mov_b32 v214, 0
    v_mov_b32 v215, 0
    s_nop 1
    v_mfma_f32_16x16x32_bf16 v[212:215], v[80:83], v[8:11], v[212:215]
    v_mfma_f32_16x16x32_bf16 v[212:215], v[84:87], v[12:15], v[212:215]
    v_mfma_f32_16x16x32_bf16 v[212:215], v[88:91], v[16:19], v[212:215]
    v_mfma_f32_16x16x32_bf16 v[212:215], v[92:95], v[20:23], v[212:215]
    global_load_dwordx4 v[64:67], v5, s[6:7] offset:0
    global_load_dwordx4 v[68:71], v5, s[6:7] offset:256
    global_load_dwordx4 v[72:75], v5, s[6:7] offset:512
    global_load_dwordx4 v[76:79], v5, s[6:7] offset:768
    global_load_dwordx4 v[80:83], v5, s[6:7] offset:1024
    global_load_dwordx4 v[84:87], v5, s[6:7] offset:1280
    global_load_dwordx4 v[88:91], v5, s[6:7] offset:1536
    global_load_dwordx4 v[92:95], v5, s[6:7] offset:1792
    s_add_u32 s6, s6, 8192
    s_addc_u32 s7, s7, 0
    s_waitcnt vmcnt(8)
    v_mov_b32 v216, 0
    v_mov_b32 v217, 0
    v_mov_b32 v218, 0
    v_mov_b32 v219, 0
    s_nop 1
    v_mfma_f32_16x16x32_bf16 v[216:219], v[96:99], v[8:11], v[216:219]
    v_mfma_f32_16x16x32_bf16 v[216:219], v[100:103], v[12:15], v[216:219]
    v_mfma_f32_16x16x32_bf16 v[216:219], v[104:107], v[16:19], v[216:219]
    v_mfma_f32_16x16x32_bf16 v[216:219], v[108:111], v[20:23], v[216:219]
    v_mov_b32 v220, 0
    v_mov_b32 v221, 0
    v_mov_b32 v222, 0
    v_mov_b32 v223, 0
    s_nop 1
    v_mfma_f32_16x16x32_bf16 v[220:223], v[112:115], v[8:11], v[220:223]
    v_mfma_f32_16x16x32_bf16 v[220:223], v[116:119], v[12:15], v[220:223]
    v_mfma_f32_16x16x32_bf16 v[220:223], v[120:123], v[16:19], v[220:223]
    v_mfma_f32_16x16x32_bf16 v[220:223], v[124:127], v[20:23], v[220:223]
    global_load_dwordx4 v[96:99], v5, s[6:7] offset:0
    global_load_dwordx4 v[100:103], v5, s[6:7] offset:256
    global_load_dwordx4 v[104:107], v5, s[6:7] offset:512
    global_load_dwordx4 v[108:111], v5, s[6:7] offset:768
    global_load_dwordx4 v[112:115], v5, s[6:7] offset:1024
    global_load_dwordx4 v[116:119], v5, s[6:7] offset:1280
    global_load_dwordx4 v[120:123], v5, s[6:7] offset:1536
    global_load_dwordx4 v[124:127], v5, s[6:7] offset:1792
    s_add_u32 s6, s6, 8192
    s_addc_u32 s7, s7, 0
    s_nop 7
    s_nop 1
    s_mov_b32 s22, 0x3db504f3
    v_cvt_pk_bf16_f32 v6, v192, v193
    v_lshlrev_b32 v192, 16, v6
    v_and_b32 v193, 0xffff0000, v6
    v_mul_f32 v192, s22, v192
    v_mul_f32 v193, s22, v193
    v_cvt_pk_bf16_f32 v6, v192, v193
    v_lshlrev_b32 v192, 16, v6
    v_and_b32 v193, 0xffff0000, v6
    v_cvt_pk_bf16_f32 v6, v194, v195
    v_lshlrev_b32 v194, 16, v6
    v_and_b32 v195, 0xffff0000, v6
    v_mul_f32 v194, s22, v194
    v_mul_f32 v195, s22, v195
    v_cvt_pk_bf16_f32 v6, v194, v195
    v_lshlrev_b32 v194, 16, v6
    v_and_b32 v195, 0xffff0000, v6
    v_cvt_pk_bf16_f32 v6, v196, v197
    v_lshlrev_b32 v196, 16, v6
    v_and_b32 v197, 0xffff0000, v6
    v_mul_f32 v196, s22, v196
    v_mul_f32 v197, s22, v197
    v_cvt_pk_bf16_f32 v6, v196, v197
    v_lshlrev_b32 v196, 16, v6
    v_and_b32 v197, 0xffff0000, v6
    v_cvt_pk_bf16_f32 v6, v198, v199
    v_lshlrev_b32 v198, 16, v6
    v_and_b32 v199, 0xffff0000, v6
    v_mul_f32 v198, s22, v198
    v_mul_f32 v199, s22, v199
    v_cvt_pk_bf16_f32 v6, v198, v199
    v_lshlrev_b32 v198, 16, v6
    v_and_b32 v199, 0xffff0000, v6
    v_cvt_pk_bf16_f32 v6, v200, v201
    v_lshlrev_b32 v200, 16, v6
    v_and_b32 v201, 0xffff0000, v6
    v_mul_f32 v200, s22, v200
    v_mul_f32 v201, s22, v201
    v_cvt_pk_bf16_f32 v6, v200, v201
    v_lshlrev_b32 v200, 16, v6
    v_and_b32 v201, 0xffff0000, v6
    v_cvt_pk_bf16_f32 v6, v202, v203
    v_lshlrev_b32 v202, 16, v6
    v_and_b32 v203, 0xffff0000, v6
    v_mul_f32 v202, s22, v202
    v_mul_f32 v203, s22, v203
    v_cvt_pk_bf16_f32 v6, v202, v203
    v_lshlrev_b32 v202, 16, v6
    v_and_b32 v203, 0xffff0000, v6
    v_cvt_pk_bf16_f32 v6, v204, v205
    v_lshlrev_b32 v204, 16, v6
    v_and_b32 v205, 0xffff0000, v6
    v_mul_f32 v204, s22, v204
    v_mul_f32 v205, s22, v205
    v_cvt_pk_bf16_f32 v6, v204, v205
    v_lshlrev_b32 v204, 16, v6
    v_and_b32 v205, 0xffff0000, v6
    v_cvt_pk_bf16_f32 v6, v206, v207
    v_lshlrev_b32 v206, 16, v6
    v_and_b32 v207, 0xffff0000, v6
    v_mul_f32 v206, s22, v206
    v_mul_f32 v207, s22, v207
    v_cvt_pk_bf16_f32 v6, v206, v207
    v_lshlrev_b32 v206, 16, v6
    v_and_b32 v207, 0xffff0000, v6
    v_cvt_pk_bf16_f32 v6, v208, v209
    v_lshlrev_b32 v208, 16, v6
    v_and_b32 v209, 0xffff0000, v6
    v_mul_f32 v208, s22, v208
    v_mul_f32 v209, s22, v209
    v_cvt_pk_bf16_f32 v6, v208, v209
    v_lshlrev_b32 v208, 16, v6
    v_and_b32 v209, 0xffff0000, v6
    v_cvt_pk_bf16_f32 v6, v210, v211
    v_lshlrev_b32 v210, 16, v6
    v_and_b32 v211, 0xffff0000, v6
    v_mul_f32 v210, s22, v210
    v_mul_f32 v211, s22, v211
    v_cvt_pk_bf16_f32 v6, v210, v211
    v_lshlrev_b32 v210, 16, v6
    v_and_b32 v211, 0xffff0000, v6
    v_cvt_pk_bf16_f32 v6, v212, v213
    v_lshlrev_b32 v212, 16, v6
    v_and_b32 v213, 0xffff0000, v6
    v_mul_f32 v212, s22, v212
    v_mul_f32 v213, s22, v213
    v_cvt_pk_bf16_f32 v6, v212, v213
    v_lshlrev_b32 v212, 16, v6
    v_and_b32 v213, 0xffff0000, v6
    v_cvt_pk_bf16_f32 v6, v214, v215
    v_lshlrev_b32 v214, 16, v6
    v_and_b32 v215, 0xffff0000, v6
    v_mul_f32 v214, s22, v214
    v_mul_f32 v215, s22, v215
    v_cvt_pk_bf16_f32 v6, v214, v215
    v_lshlrev_b32 v214, 16, v6
    v_and_b32 v215, 0xffff0000, v6
    v_cvt_pk_bf16_f32 v6, v216, v217
    v_lshlrev_b32 v216, 16, v6
    v_and_b32 v217, 0xffff0000, v6
    v_mul_f32 v216, s22, v216
    v_mul_f32 v217, s22, v217
    v_cvt_pk_bf16_f32 v6, v216, v217
    v_lshlrev_b32 v216, 16, v6
    v_and_b32 v217, 0xffff0000, v6
    v_cvt_pk_bf16_f32 v6, v218, v219
    v_lshlrev_b32 v218, 16, v6
    v_and_b32 v219, 0xffff0000, v6
    v_mul_f32 v218, s22, v218
    v_mul_f32 v219, s22, v219
    v_cvt_pk_bf16_f32 v6, v218, v219
    v_lshlrev_b32 v218, 16, v6
    v_and_b32 v219, 0xffff0000, v6
    v_cvt_pk_bf16_f32 v6, v220, v221
    v_lshlrev_b32 v220, 16, v6
    v_and_b32 v221, 0xffff0000, v6
    v_mul_f32 v220, s22, v220
    v_mul_f32 v221, s22, v221
    v_cvt_pk_bf16_f32 v6, v220, v221
    v_lshlrev_b32 v220, 16, v6
    v_and_b32 v221, 0xffff0000, v6
    v_cvt_pk_bf16_f32 v6, v222, v223
    v_lshlrev_b32 v222, 16, v6
    v_and_b32 v223, 0xffff0000, v6
    v_mul_f32 v222, s22, v222
    v_mul_f32 v223, s22, v223
    v_cvt_pk_bf16_f32 v6, v222, v223
    v_lshlrev_b32 v222, 16, v6
    v_and_b32 v223, 0xffff0000, v6
    v_max_f32 v6, v192, v193
    v_max3_f32 v6, v6, v194, v195
    v_max3_f32 v6, v6, v196, v197
    v_max3_f32 v6, v6, v198, v199
    v_max3_f32 v6, v6, v200, v201
    v_max3_f32 v6, v6, v202, v203
    v_max3_f32 v6, v6, v204, v205
    v_max3_f32 v6, v6, v206, v207
    v_max3_f32 v6, v6, v208, v209
    v_max3_f32 v6, v6, v210, v211
    v_max3_f32 v6, v6, v212, v213
    v_max3_f32 v6, v6, v214, v215
    v_max3_f32 v6, v6, v216, v217
    v_max3_f32 v6, v6, v218, v219
    v_max3_f32 v6, v6, v220, v221
    v_max3_f32 v6, v6, v222, v223
    v_xor_b32 v7, 16, v1
    v_lshlrev_b32 v7, 2, v7
    ds_bpermute_b32 v16, v7, v6
    s_waitcnt lgkmcnt(0)
    v_max_f32 v6, v6, v16
    v_xor_b32 v17, 32, v1
    v_lshlrev_b32 v17, 2, v17
    ds_bpermute_b32 v16, v17, v6
    s_waitcnt lgkmcnt(0)
    v_max_f32 v6, v6, v16
    s_mov_b32 s23, 0x3fb8aa3b
    v_mov_b32 v18, 0
    v_sub_f32 v192, v192, v6
    v_mul_f32 v192, s23, v192
    v_exp_f32 v192, v192
    v_sub_f32 v193, v193, v6
    v_mul_f32 v193, s23, v193
    v_exp_f32 v193, v193
    v_sub_f32 v194, v194, v6
    v_mul_f32 v194, s23, v194
    v_exp_f32 v194, v194
    v_sub_f32 v195, v195, v6
    v_mul_f32 v195, s23, v195
    v_exp_f32 v195, v195
    v_sub_f32 v196, v196, v6
    v_mul_f32 v196, s23, v196
    v_exp_f32 v196, v196
    v_sub_f32 v197, v197, v6
    v_mul_f32 v197, s23, v197
    v_exp_f32 v197, v197
    v_sub_f32 v198, v198, v6
    v_mul_f32 v198, s23, v198
    v_exp_f32 v198, v198
    v_sub_f32 v199, v199, v6
    v_mul_f32 v199, s23, v199
    v_exp_f32 v199, v199
    v_sub_f32 v200, v200, v6
    v_mul_f32 v200, s23, v200
    v_exp_f32 v200, v200
    v_sub_f32 v201, v201, v6
    v_mul_f32 v201, s23, v201
    v_exp_f32 v201, v201
    v_sub_f32 v202, v202, v6
    v_mul_f32 v202, s23, v202
    v_exp_f32 v202, v202
    v_sub_f32 v203, v203, v6
    v_mul_f32 v203, s23, v203
    v_exp_f32 v203, v203
    v_sub_f32 v204, v204, v6
    v_mul_f32 v204, s23, v204
    v_exp_f32 v204, v204
    v_sub_f32 v205, v205, v6
    v_mul_f32 v205, s23, v205
    v_exp_f32 v205, v205
    v_sub_f32 v206, v206, v6
    v_mul_f32 v206, s23, v206
    v_exp_f32 v206, v206
    v_sub_f32 v207, v207, v6
    v_mul_f32 v207, s23, v207
    v_exp_f32 v207, v207
    v_sub_f32 v208, v208, v6
    v_mul_f32 v208, s23, v208
    v_exp_f32 v208, v208
    v_sub_f32 v209, v209, v6
    v_mul_f32 v209, s23, v209
    v_exp_f32 v209, v209
    v_sub_f32 v210, v210, v6
    v_mul_f32 v210, s23, v210
    v_exp_f32 v210, v210
    v_sub_f32 v211, v211, v6
    v_mul_f32 v211, s23, v211
    v_exp_f32 v211, v211
    v_sub_f32 v212, v212, v6
    v_mul_f32 v212, s23, v212
    v_exp_f32 v212, v212
    v_sub_f32 v213, v213, v6
    v_mul_f32 v213, s23, v213
    v_exp_f32 v213, v213
    v_sub_f32 v214, v214, v6
    v_mul_f32 v214, s23, v214
    v_exp_f32 v214, v214
    v_sub_f32 v215, v215, v6
    v_mul_f32 v215, s23, v215
    v_exp_f32 v215, v215
    v_sub_f32 v216, v216, v6
    v_mul_f32 v216, s23, v216
    v_exp_f32 v216, v216
    v_sub_f32 v217, v217, v6
    v_mul_f32 v217, s23, v217
    v_exp_f32 v217, v217
    v_sub_f32 v218, v218, v6
    v_mul_f32 v218, s23, v218
    v_exp_f32 v218, v218
    v_sub_f32 v219, v219, v6
    v_mul_f32 v219, s23, v219
    v_exp_f32 v219, v219
    v_sub_f32 v220, v220, v6
    v_mul_f32 v220, s23, v220
    v_exp_f32 v220, v220
    v_sub_f32 v221, v221, v6
    v_mul_f32 v221, s23, v221
    v_exp_f32 v221, v221
    v_sub_f32 v222, v222, v6
    v_mul_f32 v222, s23, v222
    v_exp_f32 v222, v222
    v_sub_f32 v223, v223, v6
    v_mul_f32 v223, s23, v223
    v_exp_f32 v223, v223
    v_add_f32 v18, v18, v192
    v_add_f32 v18, v18, v193
    v_add_f32 v18, v18, v194
    v_add_f32 v18, v18, v195
    v_add_f32 v18, v18, v196
    v_add_f32 v18, v18, v197
    v_add_f32 v18, v18, v198
    v_add_f32 v18, v18, v199
    v_add_f32 v18, v18, v200
    v_add_f32 v18, v18, v201
    v_add_f32 v18, v18, v202
    v_add_f32 v18, v18, v203
    v_add_f32 v18, v18, v204
    v_add_f32 v18, v18, v205
    v_add_f32 v18, v18, v206
    v_add_f32 v18, v18, v207
    v_add_f32 v18, v18, v208
    v_add_f32 v18, v18, v209
    v_add_f32 v18, v18, v210
    v_add_f32 v18, v18, v211
    v_add_f32 v18, v18, v212
    v_add_f32 v18, v18, v213
    v_add_f32 v18, v18, v214
    v_add_f32 v18, v18, v215
    v_add_f32 v18, v18, v216
    v_add_f32 v18, v18, v217
    v_add_f32 v18, v18, v218
    v_add_f32 v18, v18, v219
    v_add_f32 v18, v18, v220
    v_add_f32 v18, v18, v221
    v_add_f32 v18, v18, v222
    v_add_f32 v18, v18, v223
    ds_bpermute_b32 v16, v7, v18
    s_waitcnt lgkmcnt(0)
    v_add_f32 v18, v18, v16
    ds_bpermute_b32 v16, v17, v18
    s_waitcnt lgkmcnt(0)
    v_add_f32 v18, v18, v16
    v_cvt_pk_bf16_f32 v192, v192, v193
    v_cvt_pk_bf16_f32 v193, v194, v195
    v_cvt_pk_bf16_f32 v194, v196, v197
    v_cvt_pk_bf16_f32 v195, v198, v199
    v_cvt_pk_bf16_f32 v196, v200, v201
    v_cvt_pk_bf16_f32 v197, v202, v203
    v_cvt_pk_bf16_f32 v198, v204, v205
    v_cvt_pk_bf16_f32 v199, v206, v207
    v_cvt_pk_bf16_f32 v200, v208, v209
    v_cvt_pk_bf16_f32 v201, v210, v211
    v_cvt_pk_bf16_f32 v202, v212, v213
    v_cvt_pk_bf16_f32 v203, v214, v215
    v_cvt_pk_bf16_f32 v204, v216, v217
    v_cvt_pk_bf16_f32 v205, v218, v219
    v_cvt_pk_bf16_f32 v206, v220, v221
    v_cvt_pk_bf16_f32 v207, v222, v223
    v_perm_b32 v24, v132, v128, s20
    v_perm_b32 v25, v140, v136, s20
    v_perm_b32 v26, v148, v144, s20
    v_perm_b32 v27, v156, v152, s20
    s_nop 1
    v_mfma_f32_16x16x32_bf16 v[224:227], v[192:195], v[24:27], v[224:227]
    v_perm_b32 v28, v132, v128, s21
    v_perm_b32 v29, v140, v136, s21
    v_perm_b32 v30, v148, v144, s21
    v_perm_b32 v31, v156, v152, s21
    s_nop 1
    v_mfma_f32_16x16x32_bf16 v[228:231], v[192:195], v[28:31], v[228:231]
    v_perm_b32 v24, v133, v129, s20
    v_perm_b32 v25, v141, v137, s20
    v_perm_b32 v26, v149, v145, s20
    v_perm_b32 v27, v157, v153, s20
    s_nop 1
    v_mfma_f32_16x16x32_bf16 v[232:235], v[192:195], v[24:27], v[232:235]
    v_perm_b32 v28, v133, v129, s21
    v_perm_b32 v29, v141, v137, s21
    v_perm_b32 v30, v149, v145, s21
    v_perm_b32 v31, v157, v153, s21
    s_nop 1
    v_mfma_f32_16x16x32_bf16 v[236:239], v[192:195], v[28:31], v[236:239]
    v_perm_b32 v24, v134, v130, s20
    v_perm_b32 v25, v142, v138, s20
    v_perm_b32 v26, v150, v146, s20
    v_perm_b32 v27, v158, v154, s20
    s_nop 1
    v_mfma_f32_16x16x32_bf16 v[240:243], v[192:195], v[24:27], v[240:243]
    v_perm_b32 v28, v134, v130, s21
    v_perm_b32 v29, v142, v138, s21
    v_perm_b32 v30, v150, v146, s21
    v_perm_b32 v31, v158, v154, s21
    s_nop 1
    v_mfma_f32_16x16x32_bf16 v[244:247], v[192:195], v[28:31], v[244:247]
    v_perm_b32 v24, v135, v131, s20
    v_perm_b32 v25, v143, v139, s20
    v_perm_b32 v26, v151, v147, s20
    v_perm_b32 v27, v159, v155, s20
    s_nop 1
    v_mfma_f32_16x16x32_bf16 v[248:251], v[192:195], v[24:27], v[248:251]
    v_perm_b32 v28, v135, v131, s21
    v_perm_b32 v29, v143, v139, s21
    v_perm_b32 v30, v151, v147, s21
    v_perm_b32 v31, v159, v155, s21
    s_nop 1
    v_mfma_f32_16x16x32_bf16 v[252:255], v[192:195], v[28:31], v[252:255]
    v_perm_b32 v24, v164, v160, s20
    v_perm_b32 v25, v172, v168, s20
    v_perm_b32 v26, v180, v176, s20
    v_perm_b32 v27, v188, v184, s20
    s_nop 1
    v_mfma_f32_16x16x32_bf16 v[224:227], v[196:199], v[24:27], v[224:227]
    v_perm_b32 v28, v164, v160, s21
    v_perm_b32 v29, v172, v168, s21
    v_perm_b32 v30, v180, v176, s21
    v_perm_b32 v31, v188, v184, s21
    s_nop 1
    v_mfma_f32_16x16x32_bf16 v[228:231], v[196:199], v[28:31], v[228:231]
    v_perm_b32 v24, v165, v161, s20
    v_perm_b32 v25, v173, v169, s20
    v_perm_b32 v26, v181, v177, s20
    v_perm_b32 v27, v189, v185, s20
    s_nop 1
    v_mfma_f32_16x16x32_bf16 v[232:235], v[196:199], v[24:27], v[232:235]
    v_perm_b32 v28, v165, v161, s21
    v_perm_b32 v29, v173, v169, s21
    v_perm_b32 v30, v181, v177, s21
    v_perm_b32 v31, v189, v185, s21
    s_nop 1
    v_mfma_f32_16x16x32_bf16 v[236:239], v[196:199], v[28:31], v[236:239]
    v_perm_b32 v24, v166, v162, s20
    v_perm_b32 v25, v174, v170, s20
    v_perm_b32 v26, v182, v178, s20
    v_perm_b32 v27, v190, v186, s20
    s_nop 1
    v_mfma_f32_16x16x32_bf16 v[240:243], v[196:199], v[24:27], v[240:243]
    v_perm_b32 v28, v166, v162, s21
    v_perm_b32 v29, v174, v170, s21
    v_perm_b32 v30, v182, v178, s21
    v_perm_b32 v31, v190, v186, s21
    s_nop 1
    v_mfma_f32_16x16x32_bf16 v[244:247], v[196:199], v[28:31], v[244:247]
    v_perm_b32 v24, v167, v163, s20
    v_perm_b32 v25, v175, v171, s20
    v_perm_b32 v26, v183, v179, s20
    v_perm_b32 v27, v191, v187, s20
    s_nop 1
    v_mfma_f32_16x16x32_bf16 v[248:251], v[196:199], v[24:27], v[248:251]
    v_perm_b32 v28, v167, v163, s21
    v_perm_b32 v29, v175, v171, s21
    v_perm_b32 v30, v183, v179, s21
    v_perm_b32 v31, v191, v187, s21
    s_nop 1
    v_mfma_f32_16x16x32_bf16 v[252:255], v[196:199], v[28:31], v[252:255]
    s_waitcnt vmcnt(8)
    v_perm_b32 v24, v68, v64, s20
    v_perm_b32 v25, v76, v72, s20
    v_perm_b32 v26, v84, v80, s20
    v_perm_b32 v27, v92, v88, s20
    s_nop 1
    v_mfma_f32_16x16x32_bf16 v[224:227], v[200:203], v[24:27], v[224:227]
    v_perm_b32 v28, v68, v64, s21
    v_perm_b32 v29, v76, v72, s21
    v_perm_b32 v30, v84, v80, s21
    v_perm_b32 v31, v92, v88, s21
    s_nop 1
    v_mfma_f32_16x16x32_bf16 v[228:231], v[200:203], v[28:31], v[228:231]
    v_perm_b32 v24, v69, v65, s20
    v_perm_b32 v25, v77, v73, s20
    v_perm_b32 v26, v85, v81, s20
    v_perm_b32 v27, v93, v89, s20
    s_nop 1
    v_mfma_f32_16x16x32_bf16 v[232:235], v[200:203], v[24:27], v[232:235]
    v_perm_b32 v28, v69, v65, s21
    v_perm_b32 v29, v77, v73, s21
    v_perm_b32 v30, v85, v81, s21
    v_perm_b32 v31, v93, v89, s21
    s_nop 1
    v_mfma_f32_16x16x32_bf16 v[236:239], v[200:203], v[28:31], v[236:239]
    v_perm_b32 v24, v70, v66, s20
    v_perm_b32 v25, v78, v74, s20
    v_perm_b32 v26, v86, v82, s20
    v_perm_b32 v27, v94, v90, s20
    s_nop 1
    v_mfma_f32_16x16x32_bf16 v[240:243], v[200:203], v[24:27], v[240:243]
    v_perm_b32 v28, v70, v66, s21
    v_perm_b32 v29, v78, v74, s21
    v_perm_b32 v30, v86, v82, s21
    v_perm_b32 v31, v94, v90, s21
    s_nop 1
    v_mfma_f32_16x16x32_bf16 v[244:247], v[200:203], v[28:31], v[244:247]
    v_perm_b32 v24, v71, v67, s20
    v_perm_b32 v25, v79, v75, s20
    v_perm_b32 v26, v87, v83, s20
    v_perm_b32 v27, v95, v91, s20
    s_nop 1
    v_mfma_f32_16x16x32_bf16 v[248:251], v[200:203], v[24:27], v[248:251]
    v_perm_b32 v28, v71, v67, s21
    v_perm_b32 v29, v79, v75, s21
    v_perm_b32 v30, v87, v83, s21
    v_perm_b32 v31, v95, v91, s21
    s_nop 1
    v_mfma_f32_16x16x32_bf16 v[252:255], v[200:203], v[28:31], v[252:255]
    s_waitcnt vmcnt(0)
    v_perm_b32 v24, v100, v96, s20
    v_perm_b32 v25, v108, v104, s20
    v_perm_b32 v26, v116, v112, s20
    v_perm_b32 v27, v124, v120, s20
    s_nop 1
    v_mfma_f32_16x16x32_bf16 v[224:227], v[204:207], v[24:27], v[224:227]
    v_perm_b32 v28, v100, v96, s21
    v_perm_b32 v29, v108, v104, s21
    v_perm_b32 v30, v116, v112, s21
    v_perm_b32 v31, v124, v120, s21
    s_nop 1
    v_mfma_f32_16x16x32_bf16 v[228:231], v[204:207], v[28:31], v[228:231]
    v_perm_b32 v24, v101, v97, s20
    v_perm_b32 v25, v109, v105, s20
    v_perm_b32 v26, v117, v113, s20
    v_perm_b32 v27, v125, v121, s20
    s_nop 1
    v_mfma_f32_16x16x32_bf16 v[232:235], v[204:207], v[24:27], v[232:235]
    v_perm_b32 v28, v101, v97, s21
    v_perm_b32 v29, v109, v105, s21
    v_perm_b32 v30, v117, v113, s21
    v_perm_b32 v31, v125, v121, s21
    s_nop 1
    v_mfma_f32_16x16x32_bf16 v[236:239], v[204:207], v[28:31], v[236:239]
    v_perm_b32 v24, v102, v98, s20
    v_perm_b32 v25, v110, v106, s20
    v_perm_b32 v26, v118, v114, s20
    v_perm_b32 v27, v126, v122, s20
    s_nop 1
    v_mfma_f32_16x16x32_bf16 v[240:243], v[204:207], v[24:27], v[240:243]
    v_perm_b32 v28, v102, v98, s21
    v_perm_b32 v29, v110, v106, s21
    v_perm_b32 v30, v118, v114, s21
    v_perm_b32 v31, v126, v122, s21
    s_nop 1
    v_mfma_f32_16x16x32_bf16 v[244:247], v[204:207], v[28:31], v[244:247]
    v_perm_b32 v24, v103, v99, s20
    v_perm_b32 v25, v111, v107, s20
    v_perm_b32 v26, v119, v115, s20
    v_perm_b32 v27, v127, v123, s20
    s_nop 1
    v_mfma_f32_16x16x32_bf16 v[248:251], v[204:207], v[24:27], v[248:251]
    v_perm_b32 v28, v103, v99, s21
    v_perm_b32 v29, v111, v107, s21
    v_perm_b32 v30, v119, v115, s21
    v_perm_b32 v31, v127, v123, s21
    s_nop 1
    v_mfma_f32_16x16x32_bf16 v[252:255], v[204:207], v[28:31], v[252:255]
    s_nop 7
    s_nop 1
    s_lshl_b32 s16, s14, 11
    s_add_u32 s16, s16, 2048
    v_lshlrev_b32 v7, 5, v3
    v_add_u32 v7, s16, v7
    v_cmp_gt_u32 vcc, 16, v1
    s_and_saveexec_b64 s[24:25], vcc
    v_mov_b32 v64, v224
    v_mov_b32 v65, v228
    v_mov_b32 v66, v232
    v_mov_b32 v67, v236
    v_mov_b32 v68, v240
    v_mov_b32 v69, v244
    v_mov_b32 v70, v248
    v_mov_b32 v71, v252
    ds_write_b128 v7, v[64:67] offset:0
    ds_write_b128 v7, v[68:71] offset:16
    s_nop 1
    v_mov_b32 v64, v225
    v_mov_b32 v65, v229
    v_mov_b32 v66, v233
    v_mov_b32 v67, v237
    v_mov_b32 v68, v241
    v_mov_b32 v69, v245
    v_mov_b32 v70, v249
    v_mov_b32 v71, v253
    ds_write_b128 v7, v[64:67] offset:512
    ds_write_b128 v7, v[68:71] offset:528
    s_nop 1
    v_mov_b32 v64, v226
    v_mov_b32 v65, v230
    v_mov_b32 v66, v234
    v_mov_b32 v67, v238
    v_mov_b32 v68, v242
    v_mov_b32 v69, v246
    v_mov_b32 v70, v250
    v_mov_b32 v71, v254
    ds_write_b128 v7, v[64:67] offset:1024
    ds_write_b128 v7, v[68:71] offset:1040
    s_nop 1
    v_mov_b32 v64, v227
    v_mov_b32 v65, v231
    v_mov_b32 v66, v235
    v_mov_b32 v67, v239
    v_mov_b32 v68, v243
    v_mov_b32 v69, v247
    v_mov_b32 v70, v251
    v_mov_b32 v71, v255
    ds_write_b128 v7, v[64:67] offset:1536
    ds_write_b128 v7, v[68:71] offset:1552
    s_nop 1
    v_cmp_gt_u32 vcc, 4, v1
    s_and_b64 exec, exec, vcc
    s_lshl_b32 s16, s14, 5
    v_lshlrev_b32 v7, 3, v3
    v_add_u32 v7, s16, v7
    v_mov_b32 v19, v18
    v_mov_b32 v18, v6
    ds_write_b64 v7, v[18:19] offset:1024
    s_mov_b64 exec, -1
    s_waitcnt lgkmcnt(0)
    s_barrier
    v_lshrrev_b32 v7, 7, v0
    v_lshlrev_b32 v7, 3, v7
    ds_read_b64 v[64:65], v7 offset:1024
    ds_read_b64 v[66:67], v7 offset:1056
    ds_read_b64 v[68:69], v7 offset:1088
    ds_read_b64 v[70:71], v7 offset:1120
    ds_read_b64 v[72:73], v7 offset:1152
    ds_read_b64 v[74:75], v7 offset:1184
    ds_read_b64 v[76:77], v7 offset:1216
    ds_read_b64 v[78:79], v7 offset:1248
    v_lshlrev_b32 v6, 2, v0
    ds_read_b32 v80, v6 offset:2048
    ds_read_b32 v81, v6 offset:4096
    ds_read_b32 v82, v6 offset:6144
    ds_read_b32 v83, v6 offset:8192
    ds_read_b32 v84, v6 offset:10240
    ds_read_b32 v85, v6 offset:12288
    ds_read_b32 v86, v6 offset:14336
    ds_read_b32 v87, v6 offset:16384
    s_waitcnt lgkmcnt(0)
    v_max_f32 v16, v64, v66
    v_max_f32 v16, v16, v68
    v_max_f32 v16, v16, v70
    v_max_f32 v16, v16, v72
    v_max_f32 v16, v16, v74
    v_max_f32 v16, v16, v76
    v_max_f32 v16, v16, v78
    v_mov_b32 v17, 0
    v_mov_b32 v18, 0
    v_sub_f32 v19, v64, v16
    v_mul_f32 v19, s23, v19
    v_exp_f32 v19, v19
    s_nop 0
    v_fmac_f32 v17, v19, v65
    v_fmac_f32 v18, v19, v80
    v_sub_f32 v19, v66, v16
    v_mul_f32 v19, s23, v19
    v_exp_f32 v19, v19
    s_nop 0
    v_fmac_f32 v17, v19, v67
    v_fmac_f32 v18, v19, v81
    v_sub_f32 v19, v68, v16
    v_mul_f32 v19, s23, v19
    v_exp_f32 v19, v19
    s_nop 0
    v_fmac_f32 v17, v19, v69
    v_fmac_f32 v18, v19, v82
    v_sub_f32 v19, v70, v16
    v_mul_f32 v19, s23, v19
    v_exp_f32 v19, v19
    s_nop 0
    v_fmac_f32 v17, v19, v71
    v_fmac_f32 v18, v19, v83
    v_sub_f32 v19, v72, v16
    v_mul_f32 v19, s23, v19
    v_exp_f32 v19, v19
    s_nop 0
    v_fmac_f32 v17, v19, v73
    v_fmac_f32 v18, v19, v84
    v_sub_f32 v19, v74, v16
    v_mul_f32 v19, s23, v19
    v_exp_f32 v19, v19
    s_nop 0
    v_fmac_f32 v17, v19, v75
    v_fmac_f32 v18, v19, v85
    v_sub_f32 v19, v76, v16
    v_mul_f32 v19, s23, v19
    v_exp_f32 v19, v19
    s_nop 0
    v_fmac_f32 v17, v19, v77
    v_fmac_f32 v18, v19, v86
    v_sub_f32 v19, v78, v16
    v_mul_f32 v19, s23, v19
    v_exp_f32 v19, v19
    s_nop 0
    v_fmac_f32 v17, v19, v79
    v_fmac_f32 v18, v19, v87
    s_lshl_b32 s16, s12, 4
    s_add_u32 s16, s16, s13
    v_lshrrev_b32 v7, 7, v0
    v_lshlrev_b32 v7, 2, v7
    v_add_u32 v7, s16, v7
    v_and_b32 v19, 127, v0
    v_lshlrev_b32 v20, 9, v7
    v_lshl_add_u32 v20, v19, 2, v20
    v_add_u32 v20, 2097152, v20
    global_store_dword v20, v18, s[10:11]
    v_cmp_eq_u32 vcc, 0, v19
    s_and_b64 exec, exec, vcc
    v_lshlrev_b32 v20, 3, v7
    v_add_u32 v20, 2621440, v20
    global_store_dwordx2 v20, v[16:17], s[10:11]
k2_end:
    s_endpgm
.globl k3_kernel
.p2align 8
.type k3_kernel,@function
k3_kernel:
    s_cmp_ge_u32 s2, 184
    s_cbranch_scc1 k3_end
    s_load_dwordx2 s[6:7], s[0:1], 32
    s_load_dwordx2 s[8:9], s[0:1], 64
    s_load_dwordx2 s[26:27], s[0:1], 56
    s_load_dwordx2 s[10:11], s[0:1], 96
    s_mov_b32 s20, 84148480
    s_mov_b32 s21, 117834498
    s_lshr_b32 s12, s2, 2
    s_and_b32 s13, s2, 3
    v_lshrrev_b32 v1, 6, v0
    s_nop 0
    v_readfirstlane_b32 s14, v1
    v_and_b32 v1, 63, v0
    v_lshrrev_b32 v2, 4, v1
    v_and_b32 v3, 15, v1
    v_lshrrev_b32 v6, 5, v0
    v_and_b32 v7, 31, v0
    s_waitcnt lgkmcnt(0)
    s_cmp_ge_u32 s12, 32
    s_cbranch_scc1 k3_ffn
    s_lshl_b32 s16, s12, 17
    s_branch k3_w
k3_ffn:
    s_mov_b32 s6, s8
    s_mov_b32 s7, s9
    s_sub_u32 s16, s12, 32
    s_lshl_b32 s16, s16, 17
k3_w:
    s_lshl_b32 s17, s14, 15
    s_add_u32 s16, s16, s17
    s_lshl_b32 s17, s13, 8
    s_add_u32 s16, s16, s17
    s_add_u32 s6, s6, s16
    s_addc_u32 s7, s7, 0
    v_lshlrev_b32 v4, 13, v2
    v_lshl_add_u32 v4, v3, 4, v4
    global_load_dwordx4 v[64:67], v4, s[6:7] offset:0
    global_load_dwordx4 v[68:71], v4, s[6:7] offset:1024
    global_load_dwordx4 v[72:75], v4, s[6:7] offset:2048
    global_load_dwordx4 v[76:79], v4, s[6:7] offset:3072
    v_add_u32 v4, 4096, v4
    global_load_dwordx4 v[80:83], v4, s[6:7] offset:0
    global_load_dwordx4 v[84:87], v4, s[6:7] offset:1024
    global_load_dwordx4 v[88:91], v4, s[6:7] offset:2048
    global_load_dwordx4 v[92:95], v4, s[6:7] offset:3072
    s_cmp_ge_u32 s12, 32
    s_cbranch_scc1 k3_ffn2
    v_lshlrev_b32 v8, 5, v6
    v_add_u32 v8, s12, v8
    v_lshlrev_b32 v9, 11, v8
    v_lshl_add_u32 v9, v7, 4, v9
    v_add_u32 v9, 2097152, v9
    v_lshlrev_b32 v10, 5, v8
    v_add_u32 v10, 2621440, v10
    global_load_dwordx4 v[16:19], v9, s[10:11] offset:0
    global_load_dwordx2 v[32:33], v10, s[10:11] offset:0
    global_load_dwordx4 v[20:23], v9, s[10:11] offset:512
    global_load_dwordx2 v[34:35], v10, s[10:11] offset:8
    global_load_dwordx4 v[24:27], v9, s[10:11] offset:1024
    global_load_dwordx2 v[36:37], v10, s[10:11] offset:16
    global_load_dwordx4 v[28:31], v9, s[10:11] offset:1536
    global_load_dwordx2 v[38:39], v10, s[10:11] offset:24
    s_waitcnt vmcnt(0)
    v_max_f32 v40, v32, v34
    v_max3_f32 v40, v40, v36, v38
    s_mov_b32 s23, 0x3fb8aa3b
    v_mov_b32 v41, 0
    v_mov_b32 v44, 0
    v_mov_b32 v45, 0
    v_mov_b32 v46, 0
    v_mov_b32 v47, 0
    v_sub_f32 v42, v32, v40
    v_mul_f32 v42, s23, v42
    v_exp_f32 v42, v42
    s_nop 0
    v_fmac_f32 v41, v42, v33
    v_fmac_f32 v44, v42, v16
    v_fmac_f32 v45, v42, v17
    v_fmac_f32 v46, v42, v18
    v_fmac_f32 v47, v42, v19
    v_sub_f32 v42, v34, v40
    v_mul_f32 v42, s23, v42
    v_exp_f32 v42, v42
    s_nop 0
    v_fmac_f32 v41, v42, v35
    v_fmac_f32 v44, v42, v20
    v_fmac_f32 v45, v42, v21
    v_fmac_f32 v46, v42, v22
    v_fmac_f32 v47, v42, v23
    v_sub_f32 v42, v36, v40
    v_mul_f32 v42, s23, v42
    v_exp_f32 v42, v42
    s_nop 0
    v_fmac_f32 v41, v42, v37
    v_fmac_f32 v44, v42, v24
    v_fmac_f32 v45, v42, v25
    v_fmac_f32 v46, v42, v26
    v_fmac_f32 v47, v42, v27
    v_sub_f32 v42, v38, v40
    v_mul_f32 v42, s23, v42
    v_exp_f32 v42, v42
    s_nop 0
    v_fmac_f32 v41, v42, v39
    v_fmac_f32 v44, v42, v28
    v_fmac_f32 v45, v42, v29
    v_fmac_f32 v46, v42, v30
    v_fmac_f32 v47, v42, v31
    v_rcp_f32 v41, v41
    s_nop 0
    v_mul_f32 v44, v41, v44
    v_mul_f32 v45, v41, v45
    v_mul_f32 v46, v41, v46
    v_mul_f32 v47, v41, v47
    s_branch k3_pack
k3_ffn2:
    s_sub_u32 s16, s12, 32
    s_lshl_b32 s16, s16, 9
    v_mul_u32_u24 v9, 7168, v6
    v_lshl_add_u32 v9, v7, 4, v9
    v_add_u32 v9, s16, v9
    v_add_u32 v9, 1048576, v9
    global_load_dwordx4 v[16:19], v9, s[10:11]
    v_add_u32 v9, 57344, v9
    global_load_dwordx4 v[20:23], v9, s[10:11]
    v_add_u32 v9, 57344, v9
    global_load_dwordx4 v[24:27], v9, s[10:11]
    v_add_u32 v9, 57344, v9
    global_load_dwordx4 v[28:31], v9, s[10:11]
    v_add_u32 v9, 57344, v9
    global_load_dwordx4 v[32:35], v9, s[10:11]
    v_add_u32 v9, 57344, v9
    global_load_dwordx4 v[36:39], v9, s[10:11]
    v_add_u32 v9, 57344, v9
    global_load_dwordx4 v[40:43], v9, s[10:11]
    v_add_u32 v9, 57344, v9
    global_load_dwordx4 v[44:47], v9, s[10:11]
    v_add_u32 v9, 57344, v9
    s_lshr_b32 s16, s16, 1
    v_lshl_add_u32 v9, v7, 3, s16
    global_load_dwordx2 v[48:49], v9, s[26:27]
    s_waitcnt vmcnt(0)
    v_lshlrev_b32 v50, 16, v48
    v_and_b32 v51, 0xffff0000, v48
    v_lshlrev_b32 v52, 16, v49
    v_and_b32 v53, 0xffff0000, v49
    v_add_f32 v16, v16, v20
    v_add_f32 v16, v16, v24
    v_add_f32 v16, v16, v28
    v_add_f32 v16, v16, v32
    v_add_f32 v16, v16, v36
    v_add_f32 v16, v16, v40
    v_add_f32 v16, v16, v44
    v_mov_b32 v44, v16
    v_cvt_pk_bf16_f32 v54, v44, v44
    v_lshlrev_b32 v44, 16, v54
    v_add_f32 v44, v44, v50
    v_cvt_pk_bf16_f32 v54, v44, v44
    v_lshlrev_b32 v44, 16, v54
    v_mul_f32 v54, v44, v44
    v_mul_f32 v54, v54, v44
    v_fmamk_f32 v54, v54, 0x3d372713, v44
    v_mul_f32 v54, 0xc0135761, v54
    v_exp_f32 v54, v54
    s_nop 0
    v_add_f32 v54, 1.0, v54
    v_rcp_f32 v54, v54
    s_nop 0
    v_mul_f32 v44, v44, v54
    v_add_f32 v17, v17, v21
    v_add_f32 v17, v17, v25
    v_add_f32 v17, v17, v29
    v_add_f32 v17, v17, v33
    v_add_f32 v17, v17, v37
    v_add_f32 v17, v17, v41
    v_add_f32 v17, v17, v45
    v_mov_b32 v45, v17
    v_cvt_pk_bf16_f32 v54, v45, v45
    v_lshlrev_b32 v45, 16, v54
    v_add_f32 v45, v45, v51
    v_cvt_pk_bf16_f32 v54, v45, v45
    v_lshlrev_b32 v45, 16, v54
    v_mul_f32 v54, v45, v45
    v_mul_f32 v54, v54, v45
    v_fmamk_f32 v54, v54, 0x3d372713, v45
    v_mul_f32 v54, 0xc0135761, v54
    v_exp_f32 v54, v54
    s_nop 0
    v_add_f32 v54, 1.0, v54
    v_rcp_f32 v54, v54
    s_nop 0
    v_mul_f32 v45, v45, v54
    v_add_f32 v18, v18, v22
    v_add_f32 v18, v18, v26
    v_add_f32 v18, v18, v30
    v_add_f32 v18, v18, v34
    v_add_f32 v18, v18, v38
    v_add_f32 v18, v18, v42
    v_add_f32 v18, v18, v46
    v_mov_b32 v46, v18
    v_cvt_pk_bf16_f32 v54, v46, v46
    v_lshlrev_b32 v46, 16, v54
    v_add_f32 v46, v46, v52
    v_cvt_pk_bf16_f32 v54, v46, v46
    v_lshlrev_b32 v46, 16, v54
    v_mul_f32 v54, v46, v46
    v_mul_f32 v54, v54, v46
    v_fmamk_f32 v54, v54, 0x3d372713, v46
    v_mul_f32 v54, 0xc0135761, v54
    v_exp_f32 v54, v54
    s_nop 0
    v_add_f32 v54, 1.0, v54
    v_rcp_f32 v54, v54
    s_nop 0
    v_mul_f32 v46, v46, v54
    v_add_f32 v19, v19, v23
    v_add_f32 v19, v19, v27
    v_add_f32 v19, v19, v31
    v_add_f32 v19, v19, v35
    v_add_f32 v19, v19, v39
    v_add_f32 v19, v19, v43
    v_add_f32 v19, v19, v47
    v_mov_b32 v47, v19
    v_cvt_pk_bf16_f32 v54, v47, v47
    v_lshlrev_b32 v47, 16, v54
    v_add_f32 v47, v47, v53
    v_cvt_pk_bf16_f32 v54, v47, v47
    v_lshlrev_b32 v47, 16, v54
    v_mul_f32 v54, v47, v47
    v_mul_f32 v54, v54, v47
    v_fmamk_f32 v54, v54, 0x3d372713, v47
    v_mul_f32 v54, 0xc0135761, v54
    v_exp_f32 v54, v54
    s_nop 0
    v_add_f32 v54, 1.0, v54
    v_rcp_f32 v54, v54
    s_nop 0
    v_mul_f32 v47, v47, v54
k3_pack:
    v_cvt_pk_bf16_f32 v44, v44, v45
    v_cvt_pk_bf16_f32 v45, v46, v47
    v_lshlrev_b32 v9, 8, v6
    v_lshl_add_u32 v9, v7, 3, v9
    ds_write_b64 v9, v[44:45]
    s_waitcnt lgkmcnt(0)
    s_barrier
    v_and_b32 v9, 7, v3
    v_lshlrev_b32 v9, 8, v9
    v_lshl_add_u32 v9, v2, 4, v9
    s_lshl_b32 s16, s14, 6
    v_add_u32 v9, s16, v9
    ds_read_b128 v[8:11], v9
    v_cmp_gt_u32 vcc, 8, v3
    s_waitcnt vmcnt(0) lgkmcnt(0)
    v_cndmask_b32 v8, 0, v8, vcc
    v_cndmask_b32 v9, 0, v9, vcc
    v_cndmask_b32 v10, 0, v10, vcc
    v_cndmask_b32 v11, 0, v11, vcc
    v_mov_b32 v32, 0
    v_mov_b32 v33, 0
    v_mov_b32 v34, 0
    v_mov_b32 v35, 0
    v_mov_b32 v36, 0
    v_mov_b32 v37, 0
    v_mov_b32 v38, 0
    v_mov_b32 v39, 0
    v_mov_b32 v40, 0
    v_mov_b32 v41, 0
    v_mov_b32 v42, 0
    v_mov_b32 v43, 0
    v_mov_b32 v44, 0
    v_mov_b32 v45, 0
    v_mov_b32 v46, 0
    v_mov_b32 v47, 0
    v_mov_b32 v48, 0
    v_mov_b32 v49, 0
    v_mov_b32 v50, 0
    v_mov_b32 v51, 0
    v_mov_b32 v52, 0
    v_mov_b32 v53, 0
    v_mov_b32 v54, 0
    v_mov_b32 v55, 0
    v_mov_b32 v56, 0
    v_mov_b32 v57, 0
    v_mov_b32 v58, 0
    v_mov_b32 v59, 0
    v_mov_b32 v60, 0
    v_mov_b32 v61, 0
    v_mov_b32 v62, 0
    v_mov_b32 v63, 0
    v_perm_b32 v24, v68, v64, s20
    v_perm_b32 v25, v76, v72, s20
    v_perm_b32 v26, v84, v80, s20
    v_perm_b32 v27, v92, v88, s20
    s_nop 1
    v_mfma_f32_16x16x32_bf16 v[32:35], v[8:11], v[24:27], v[32:35]
    v_perm_b32 v28, v68, v64, s21
    v_perm_b32 v29, v76, v72, s21
    v_perm_b32 v30, v84, v80, s21
    v_perm_b32 v31, v92, v88, s21
    s_nop 1
    v_mfma_f32_16x16x32_bf16 v[36:39], v[8:11], v[28:31], v[36:39]
    v_perm_b32 v24, v69, v65, s20
    v_perm_b32 v25, v77, v73, s20
    v_perm_b32 v26, v85, v81, s20
    v_perm_b32 v27, v93, v89, s20
    s_nop 1
    v_mfma_f32_16x16x32_bf16 v[40:43], v[8:11], v[24:27], v[40:43]
    v_perm_b32 v28, v69, v65, s21
    v_perm_b32 v29, v77, v73, s21
    v_perm_b32 v30, v85, v81, s21
    v_perm_b32 v31, v93, v89, s21
    s_nop 1
    v_mfma_f32_16x16x32_bf16 v[44:47], v[8:11], v[28:31], v[44:47]
    v_perm_b32 v24, v70, v66, s20
    v_perm_b32 v25, v78, v74, s20
    v_perm_b32 v26, v86, v82, s20
    v_perm_b32 v27, v94, v90, s20
    s_nop 1
    v_mfma_f32_16x16x32_bf16 v[48:51], v[8:11], v[24:27], v[48:51]
    v_perm_b32 v28, v70, v66, s21
    v_perm_b32 v29, v78, v74, s21
    v_perm_b32 v30, v86, v82, s21
    v_perm_b32 v31, v94, v90, s21
    s_nop 1
    v_mfma_f32_16x16x32_bf16 v[52:55], v[8:11], v[28:31], v[52:55]
    v_perm_b32 v24, v71, v67, s20
    v_perm_b32 v25, v79, v75, s20
    v_perm_b32 v26, v87, v83, s20
    v_perm_b32 v27, v95, v91, s20
    s_nop 1
    v_mfma_f32_16x16x32_bf16 v[56:59], v[8:11], v[24:27], v[56:59]
    v_perm_b32 v28, v71, v67, s21
    v_perm_b32 v29, v79, v75, s21
    v_perm_b32 v30, v87, v83, s21
    v_perm_b32 v31, v95, v91, s21
    s_nop 1
    v_mfma_f32_16x16x32_bf16 v[60:63], v[8:11], v[28:31], v[60:63]
    s_nop 7
    s_nop 1
    v_cmp_gt_u32 vcc, 32, v1
    s_and_saveexec_b64 s[24:25], vcc
    s_lshl_b32 s16, s14, 12
    s_add_u32 s16, s16, 4096
    v_lshlrev_b32 v12, 11, v2
    v_lshl_add_u32 v12, v3, 5, v12
    v_add_u32 v12, s16, v12
    v_mov_b32 v64, v32
    v_mov_b32 v65, v36
    v_mov_b32 v66, v40
    v_mov_b32 v67, v44
    v_mov_b32 v68, v48
    v_mov_b32 v69, v52
    v_mov_b32 v70, v56
    v_mov_b32 v71, v60
    ds_write_b128 v12, v[64:67] offset:0
    ds_write_b128 v12, v[68:71] offset:16
    s_nop 1
    v_mov_b32 v64, v33
    v_mov_b32 v65, v37
    v_mov_b32 v66, v41
    v_mov_b32 v67, v45
    v_mov_b32 v68, v49
    v_mov_b32 v69, v53
    v_mov_b32 v70, v57
    v_mov_b32 v71, v61
    ds_write_b128 v12, v[64:67] offset:512
    ds_write_b128 v12, v[68:71] offset:528
    s_nop 1
    v_mov_b32 v64, v34
    v_mov_b32 v65, v38
    v_mov_b32 v66, v42
    v_mov_b32 v67, v46
    v_mov_b32 v68, v50
    v_mov_b32 v69, v54
    v_mov_b32 v70, v58
    v_mov_b32 v71, v62
    ds_write_b128 v12, v[64:67] offset:1024
    ds_write_b128 v12, v[68:71] offset:1040
    s_nop 1
    v_mov_b32 v64, v35
    v_mov_b32 v65, v39
    v_mov_b32 v66, v43
    v_mov_b32 v67, v47
    v_mov_b32 v68, v51
    v_mov_b32 v69, v55
    v_mov_b32 v70, v59
    v_mov_b32 v71, v63
    ds_write_b128 v12, v[64:67] offset:1536
    ds_write_b128 v12, v[68:71] offset:1552
    s_nop 1
    s_mov_b64 exec, -1
    s_waitcnt lgkmcnt(0)
    s_barrier
    v_lshlrev_b32 v12, 4, v0
    ds_read_b128 v[64:67], v12 offset:4096
    ds_read_b128 v[68:71], v12 offset:8192
    ds_read_b128 v[72:75], v12 offset:12288
    ds_read_b128 v[76:79], v12 offset:16384
    s_waitcnt lgkmcnt(0)
    v_add_f32 v64, v64, v68
    v_add_f32 v64, v64, v72
    v_add_f32 v64, v64, v76
    v_add_f32 v65, v65, v69
    v_add_f32 v65, v65, v73
    v_add_f32 v65, v65, v77
    v_add_f32 v66, v66, v70
    v_add_f32 v66, v66, v74
    v_add_f32 v66, v66, v78
    v_add_f32 v67, v67, v71
    v_add_f32 v67, v67, v75
    v_add_f32 v67, v67, v79
    s_lshl_b32 s16, s12, 3
    v_add_u32 v12, s16, v6
    v_lshlrev_b32 v12, 11, v12
    s_lshl_b32 s16, s13, 9
    v_add_u32 v12, s16, v12
    v_lshl_add_u32 v12, v7, 4, v12
    v_add_u32 v12, 3145728, v12
    global_store_dwordx4 v12, v[64:67], s[10:11]
k3_end:
    s_endpgm
.globl k4_kernel
.p2align 8
.type k4_kernel,@function
k4_kernel:
    s_cmp_ge_u32 s2, 16
    s_cbranch_scc1 k4_end
    s_load_dwordx2 s[4:5], s[0:1], 0
    s_load_dwordx2 s[6:7], s[0:1], 72
    s_load_dwordx2 s[8:9], s[0:1], 80
    s_load_dwordx2 s[10:11], s[0:1], 96
    s_lshl_b32 s3, s2, 8
    v_add_u32 v1, s3, v0
    v_lshlrev_b32 v2, 2, v1
    v_add_u32 v2, 3145728, v2
    s_waitcnt lgkmcnt(0)
    global_load_dword v8, v2, s[10:11]
    v_add_u32 v2, 16384, v2
    global_load_dword v9, v2, s[10:11]
    v_add_u32 v2, 16384, v2
    global_load_dword v10, v2, s[10:11]
    v_add_u32 v2, 16384, v2
    global_load_dword v11, v2, s[10:11]
    v_add_u32 v2, 16384, v2
    global_load_dword v12, v2, s[10:11]
    v_add_u32 v2, 16384, v2
    global_load_dword v13, v2, s[10:11]
    v_add_u32 v2, 16384, v2
    global_load_dword v14, v2, s[10:11]
    v_add_u32 v2, 16384, v2
    global_load_dword v15, v2, s[10:11]
    v_add_u32 v2, 16384, v2
    global_load_dword v16, v2, s[10:11]
    v_add_u32 v2, 16384, v2
    global_load_dword v17, v2, s[10:11]
    v_add_u32 v2, 16384, v2
    global_load_dword v18, v2, s[10:11]
    v_add_u32 v2, 16384, v2
    global_load_dword v19, v2, s[10:11]
    v_add_u32 v2, 16384, v2
    global_load_dword v20, v2, s[10:11]
    v_add_u32 v2, 16384, v2
    global_load_dword v21, v2, s[10:11]
    v_add_u32 v2, 16384, v2
    global_load_dword v22, v2, s[10:11]
    v_add_u32 v2, 16384, v2
    global_load_dword v23, v2, s[10:11]
    v_add_u32 v2, 16384, v2
    global_load_dword v24, v2, s[10:11]
    v_add_u32 v2, 16384, v2
    global_load_dword v25, v2, s[10:11]
    v_add_u32 v2, 16384, v2
    global_load_dword v26, v2, s[10:11]
    v_add_u32 v2, 16384, v2
    global_load_dword v27, v2, s[10:11]
    v_add_u32 v2, 16384, v2
    global_load_dword v28, v2, s[10:11]
    v_add_u32 v2, 16384, v2
    global_load_dword v29, v2, s[10:11]
    v_add_u32 v2, 16384, v2
    global_load_dword v30, v2, s[10:11]
    v_add_u32 v2, 16384, v2
    global_load_dword v31, v2, s[10:11]
    v_add_u32 v2, 16384, v2
    global_load_dword v32, v2, s[10:11]
    v_add_u32 v2, 16384, v2
    global_load_dword v33, v2, s[10:11]
    v_add_u32 v2, 16384, v2
    global_load_dword v34, v2, s[10:11]
    v_add_u32 v2, 16384, v2
    global_load_dword v35, v2, s[10:11]
    v_add_u32 v2, 16384, v2
    global_load_dword v36, v2, s[10:11]
    v_add_u32 v2, 16384, v2
    global_load_dword v37, v2, s[10:11]
    v_add_u32 v2, 16384, v2
    global_load_dword v38, v2, s[10:11]
    v_add_u32 v2, 16384, v2
    global_load_dword v39, v2, s[10:11]
    v_add_u32 v2, 16384, v2
    global_load_dword v40, v2, s[10:11]
    v_add_u32 v2, 16384, v2
    global_load_dword v41, v2, s[10:11]
    v_add_u32 v2, 16384, v2
    global_load_dword v42, v2, s[10:11]
    v_add_u32 v2, 16384, v2
    global_load_dword v43, v2, s[10:11]
    v_add_u32 v2, 16384, v2
    global_load_dword v44, v2, s[10:11]
    v_add_u32 v2, 16384, v2
    global_load_dword v45, v2, s[10:11]
    v_add_u32 v2, 16384, v2
    global_load_dword v46, v2, s[10:11]
    v_add_u32 v2, 16384, v2
    global_load_dword v47, v2, s[10:11]
    v_add_u32 v2, 16384, v2
    global_load_dword v48, v2, s[10:11]
    v_add_u32 v2, 16384, v2
    global_load_dword v49, v2, s[10:11]
    v_add_u32 v2, 16384, v2
    global_load_dword v50, v2, s[10:11]
    v_add_u32 v2, 16384, v2
    global_load_dword v51, v2, s[10:11]
    v_add_u32 v2, 16384, v2
    global_load_dword v52, v2, s[10:11]
    v_add_u32 v2, 16384, v2
    global_load_dword v53, v2, s[10:11]
    v_add_u32 v2, 16384, v2
    v_lshlrev_b32 v3, 1, v1
    global_load_ushort v4, v3, s[4:5]
    v_and_b32 v5, 511, v1
    v_lshlrev_b32 v5, 1, v5
    global_load_ushort v5, v5, s[6:7]
    s_waitcnt vmcnt(0)
    v_add_f32 v8, v8, v9
    v_add_f32 v8, v8, v10
    v_add_f32 v8, v8, v11
    v_add_f32 v8, v8, v12
    v_add_f32 v8, v8, v13
    v_add_f32 v8, v8, v14
    v_add_f32 v8, v8, v15
    v_add_f32 v8, v8, v16
    v_add_f32 v8, v8, v17
    v_add_f32 v8, v8, v18
    v_add_f32 v8, v8, v19
    v_add_f32 v8, v8, v20
    v_add_f32 v8, v8, v21
    v_add_f32 v8, v8, v22
    v_add_f32 v8, v8, v23
    v_add_f32 v8, v8, v24
    v_add_f32 v8, v8, v25
    v_add_f32 v8, v8, v26
    v_add_f32 v8, v8, v27
    v_add_f32 v8, v8, v28
    v_add_f32 v8, v8, v29
    v_add_f32 v8, v8, v30
    v_add_f32 v8, v8, v31
    v_add_f32 v8, v8, v32
    v_add_f32 v8, v8, v33
    v_add_f32 v8, v8, v34
    v_add_f32 v8, v8, v35
    v_add_f32 v8, v8, v36
    v_add_f32 v8, v8, v37
    v_add_f32 v8, v8, v38
    v_add_f32 v8, v8, v39
    v_add_f32 v40, v40, v41
    v_add_f32 v40, v40, v42
    v_add_f32 v40, v40, v43
    v_add_f32 v40, v40, v44
    v_add_f32 v40, v40, v45
    v_add_f32 v40, v40, v46
    v_add_f32 v40, v40, v47
    v_add_f32 v40, v40, v48
    v_add_f32 v40, v40, v49
    v_add_f32 v40, v40, v50
    v_add_f32 v40, v40, v51
    v_add_f32 v40, v40, v52
    v_add_f32 v40, v40, v53
    v_cvt_pk_bf16_f32 v6, v8, v8
    v_lshlrev_b32 v8, 16, v6
    v_cvt_pk_bf16_f32 v6, v40, v40
    v_lshlrev_b32 v40, 16, v6
    v_lshlrev_b32 v5, 16, v5
    v_add_f32 v40, v40, v5
    v_cvt_pk_bf16_f32 v6, v40, v40
    v_lshlrev_b32 v40, 16, v6
    v_mul_f32 v6, 0xbfb8aa3b, v40
    v_exp_f32 v6, v6
    s_nop 0
    v_add_f32 v6, 1.0, v6
    v_rcp_f32 v6, v6
    s_nop 0
    v_mul_f32 v40, v40, v6
    v_cvt_pk_bf16_f32 v6, v40, v40
    v_lshlrev_b32 v40, 16, v6
    v_mul_f32 v8, v8, v40
    v_cvt_pk_bf16_f32 v6, v8, v8
    v_lshlrev_b32 v8, 16, v6
    v_lshlrev_b32 v4, 16, v4
    v_add_f32 v8, v8, v4
    v_cvt_pk_bf16_f32 v8, v8, v8
    global_store_short v3, v8, s[8:9]
k4_end:
    s_endpgm
.section .rodata,"a"
.p2align 6
.amdhsa_kernel k1_kernel
  .amdhsa_next_free_vgpr 256
  .amdhsa_next_free_sgpr 96
  .amdhsa_accum_offset 256
  .amdhsa_group_segment_fixed_size 0
  .amdhsa_kernarg_size 104
  .amdhsa_user_sgpr_count 2
  .amdhsa_user_sgpr_kernarg_segment_ptr 1
  .amdhsa_system_sgpr_workgroup_id_x 1
.end_amdhsa_kernel
.amdhsa_kernel k2_kernel
  .amdhsa_next_free_vgpr 256
  .amdhsa_next_free_sgpr 96
  .amdhsa_accum_offset 256
  .amdhsa_group_segment_fixed_size 0
  .amdhsa_kernarg_size 104
  .amdhsa_user_sgpr_count 2
  .amdhsa_user_sgpr_kernarg_segment_ptr 1
  .amdhsa_system_sgpr_workgroup_id_x 1
.end_amdhsa_kernel
.amdhsa_kernel k3_kernel
  .amdhsa_next_free_vgpr 128
  .amdhsa_next_free_sgpr 96
  .amdhsa_accum_offset 128
  .amdhsa_group_segment_fixed_size 0
  .amdhsa_kernarg_size 104
  .amdhsa_user_sgpr_count 2
  .amdhsa_user_sgpr_kernarg_segment_ptr 1
  .amdhsa_system_sgpr_workgroup_id_x 1
.end_amdhsa_kernel
.amdhsa_kernel k4_kernel
  .amdhsa_next_free_vgpr 64
  .amdhsa_next_free_sgpr 96
  .amdhsa_accum_offset 64
  .amdhsa_group_segment_fixed_size 0
  .amdhsa_kernarg_size 104
  .amdhsa_user_sgpr_count 2
  .amdhsa_user_sgpr_kernarg_segment_ptr 1
  .amdhsa_system_sgpr_workgroup_id_x 1
.end_amdhsa_kernel
```
